```python
import torch

def _softmax(x, axis=-1):
    return torch.softmax(x, dim=axis)
def _gelu(x):
    return torch.nn.functional.gelu(x, approximate="tanh")
def _silu(x):
    return torch.nn.functional.silu(x)
def _sigmoid(x):
    return torch.sigmoid(x)
def _layernorm(x, axis=-1, eps=1e-5):
    m = x.mean(dim=axis, keepdim=True)
    v = x.var(dim=axis, keepdim=True, unbiased=False)
    return (x - m) / torch.sqrt(v + eps)
def _scatter_add(tgt, idx, src, axis=0):
    return tgt.clone().index_add_(axis, idx, src)
def _segment_sum(src, seg, n):
    out = torch.zeros((n,) + src.shape[1:], dtype=src.dtype)
    return out.index_add_(0, seg, src)
def _pad(x, pw):
    flat = tuple(v for pair in reversed(pw) for v in pair)
    return torch.nn.functional.pad(x, flat)

kernel_name = 'standalone__gqa_block_cached__near_ridge'

def setup_inputs():

    _w = (lambda a: (lambda t: t.to(torch.bfloat16) if t.is_floating_point() else t)(torch.as_tensor(a)))
    B, Sq, D = 8, 128, 576
    Hq, Hkv, Sk, Dh = 32, 16, 512, 128
    assert Hq % Hkv == 0, (Hq, Hkv)
    return {
        "x": _w((lambda *s: torch.randn(*s, dtype=torch.bfloat16) * 0.8)(B, Sq, D)),
        "k_cache": _w((lambda *s: torch.randn(*s, dtype=torch.bfloat16) * 0.8)(B, Hkv, Sk, Dh)),
        "v_cache": _w((lambda *s: torch.randn(*s, dtype=torch.bfloat16) * 0.05)(B, Hkv, Sk, Dh)),
        "wq": _w((lambda *s: torch.randn(*s, dtype=torch.bfloat16) * 0.8)(D, Hq * Dh) * (D ** -0.5)),
        "wo": _w((lambda *s: torch.randn(*s, dtype=torch.bfloat16) * 0.05)(Hq * Dh, D) * ((Hq * Dh) ** -0.5)),
    }

def reference(x, k_cache, v_cache, wq, wo):
    B, Sq, D = x.shape
    Hq, Dh = 32, 128
    Hkv = k_cache.shape[1]
    rep = Hq // Hkv
    q = (lambda x, *d: x.permute(*d))((x @ wq).reshape(B, Sq, Hq, Dh), 0, 2, 1, 3)
    k = (lambda x, n, axis: torch.repeat_interleave(x, n, dim=axis))(k_cache, rep, axis=1)
    v = (lambda x, n, axis: torch.repeat_interleave(x, n, dim=axis))(v_cache, rep, axis=1)
    scores = torch.einsum("bhqd,bhkd->bhqk", q, k) * (Dh ** -0.5)
    p = _softmax(scores, axis=-1)
    o = torch.einsum("bhqk,bhkd->bhqd", p, v)
    return (lambda x, *d: x.permute(*d))(o, 0, 2, 1, 3).reshape(B, Sq, Hq * Dh) @ wo
```

```asm
; @launch grid=(256,1,1) block=(512,1,1) lds=163840
.amdgcn_target "amdgcn-amd-amdhsa--gfx950"
.text
.globl standalone__gqa_block_cached__near_ridge_kernel
.p2align 8
.type standalone__gqa_block_cached__near_ridge_kernel,@function
standalone__gqa_block_cached__near_ridge_kernel:
s_getpc_b64 s[66:67]
L_pc:
s_cmp_ge_u32 s2, 256
s_cbranch_scc1 L_end1
s_load_dwordx16 s[4:19], s[0:1], 0
v_lshrrev_b32 v2, 8, v0
v_mul_u32_u24 v2, L_compute-standalone__gqa_block_cached__near_ridge_kernel-2048, v2
v_lshl_add_u32 v2, v0, 3, v2
v_mov_b32 v3, 0
v_lshl_add_u64 v[2:3], v[2:3], 0, s[66:67]
global_load_dword v39, v[2:3], off
v_lshrrev_b32 v1, 6, v0
v_and_b32 v0, 63, v0
v_readfirstlane_b32 s20, v1
s_and_b32 s51, s2, 7
s_lshr_b32 s54, s2, 3
s_and_b32 s52, s54, 1
s_lshl1_add_u32 s52, s51, s52
s_lshr_b32 s53, s54, 1
s_lshr_b32 s54, s54, 2
s_mul_i32 s55, s53, 73728
s_lshl_b32 s56, s52, 9
s_mov_b64 s[48:49], -1
s_cmp_lt_u32 s20, 4
s_cbranch_scc1 L_compute
s_sub_u32 s51, s20, 4
s_lshl_b32 s50, s51, 10
s_lshl_b32 s51, s51, 3
v_lshrrev_b32 v8, 3, v0
v_add_u32 v8, s51, v8
v_and_b32 v9, 7, v0
v_bfe_u32 v10, v8, 1, 3
v_xor_b32 v10, v10, v9
v_lshlrev_b32 v10, 4, v10
v_mul_u32_u24 v11, 1152, v8
v_add_u32 v2, v11, v10
v_bfe_u32 v12, v8, 3, 1
v_and_b32 v13, 2, v8
v_lshl_or_b32 v12, v12, 2, v13
v_xor_b32 v12, v12, v9
v_lshlrev_b32 v12, 4, v12
v_lshl_add_u32 v3, v8, 13, v12
s_lshl1_add_u32 s51, s52, s53
s_mul_i32 s3, s51, 57
s_lshr_b32 s3, s3, 9
s_mul_i32 s3, s3, 9
s_sub_u32 s100, s51, s3
s_lshl_b32 s100, s100, 7
L_load0:
s_mov_b32 s62, s100
s_lshl_b32 s71, s62, 12
s_sub_u32 s26, 1179648, s55
s_mov_b32 s27, 0x20000
s_sub_u32 s38, 4718592, s56
s_mov_b32 s39, s27
s_waitcnt lgkmcnt(0)
s_add_u32 s24, s4, s55
s_addc_u32 s25, s5, 0
s_add_u32 s36, s10, s56
s_addc_u32 s37, s11, 0
L_load:
s_add_u32 m0, s50, 122880
s_add_u32 s22, s62, 0
buffer_load_dwordx4 v2, s[24:27], s22 offen lds
s_add_u32 m0, s50, 126976
s_add_u32 s22, s62, 36864
buffer_load_dwordx4 v2, s[24:27], s22 offen lds
s_add_u32 m0, s50, 131072
s_add_u32 s22, s71, 0
buffer_load_dwordx4 v3, s[36:39], s22 offen lds
s_add_u32 m0, s50, 135168
s_add_u32 s22, s71, 262144
buffer_load_dwordx4 v3, s[36:39], s22 offen lds
s_add_u32 m0, s50, 139264
s_add_u32 s22, s71, 128
buffer_load_dwordx4 v3, s[36:39], s22 offen lds
s_add_u32 m0, s50, 143360
s_add_u32 s22, s71, 262272
buffer_load_dwordx4 v3, s[36:39], s22 offen lds
s_add_u32 m0, s50, 147456
s_add_u32 s22, s71, 256
buffer_load_dwordx4 v3, s[36:39], s22 offen lds
s_add_u32 m0, s50, 151552
s_add_u32 s22, s71, 262400
buffer_load_dwordx4 v3, s[36:39], s22 offen lds
s_add_u32 m0, s50, 155648
s_add_u32 s22, s71, 384
buffer_load_dwordx4 v3, s[36:39], s22 offen lds
s_add_u32 m0, s50, 159744
s_add_u32 s22, s71, 262528
buffer_load_dwordx4 v3, s[36:39], s22 offen lds
s_add_u32 s63, s62, 128
s_cmp_eq_u32 s63, 1152
s_cselect_b32 s63, 0, s63
s_lshl_b32 s72, s63, 12
s_add_u32 s64, s63, 128
s_cmp_eq_u32 s64, 1152
s_cselect_b32 s64, 0, s64
s_lshl_b32 s73, s64, 12
s_add_u32 m0, s50, 0
s_add_u32 s22, s63, 0
buffer_load_dwordx4 v2, s[24:27], s22 offen lds
s_add_u32 m0, s50, 4096
s_add_u32 s22, s63, 36864
buffer_load_dwordx4 v2, s[24:27], s22 offen lds
s_add_u32 m0, s50, 8192
s_add_u32 s22, s72, 0
buffer_load_dwordx4 v3, s[36:39], s22 offen lds
s_add_u32 m0, s50, 12288
s_add_u32 s22, s72, 262144
buffer_load_dwordx4 v3, s[36:39], s22 offen lds
s_mul_i32 s57, s52, 294912
s_lshl4_add_u32 s58, s54, s52
s_lshl_b32 s58, s58, 17
s_mul_i32 s59, s53, 1187840
s_add_u32 s59, s59, s56
s_add_u32 s65, s64, 128
s_cmp_eq_u32 s65, 1152
s_cselect_b32 s65, 0, s65
s_lshl_b32 s74, s65, 12
s_add_u32 s66, s65, 128
s_cmp_eq_u32 s66, 1152
s_cselect_b32 s66, 0, s66
s_lshl_b32 s75, s66, 12
s_add_u32 s67, s66, 128
s_cmp_eq_u32 s67, 1152
s_cselect_b32 s67, 0, s67
s_lshl_b32 s76, s67, 12
s_add_u32 s68, s67, 128
s_cmp_eq_u32 s68, 1152
s_cselect_b32 s68, 0, s68
s_lshl_b32 s77, s68, 12
s_add_u32 s69, s68, 128
s_cmp_eq_u32 s69, 1152
s_cselect_b32 s69, 0, s69
s_lshl_b32 s78, s69, 12
s_add_u32 s70, s69, 128
s_cmp_eq_u32 s70, 1152
s_cselect_b32 s70, 0, s70
s_lshl_b32 s79, s70, 12
s_add_u32 s28, s6, s58
s_addc_u32 s29, s7, 0
s_sub_u32 s30, 16777216, s58
s_mov_b32 s31, 0x20000
s_add_u32 s32, s8, s58
s_addc_u32 s33, s9, 0
s_sub_u32 s34, 16777216, s58
s_mov_b32 s35, 0x20000
s_add_u32 s40, s12, s57
s_addc_u32 s41, s13, 0
s_sub_u32 s42, 4718592, s57
s_mov_b32 s43, 0x20000
v_and_b32 v14, 6, v8
v_xor_b32 v14, v14, v9
v_lshlrev_b32 v14, 4, v14
v_lshl_add_u32 v6, v8, 8, v14
v_add_u32 v4, v11, v14
v_bfe_u32 v14, v8, 2, 1
v_lshlrev_b32 v14, 4, v14
v_xor_b32 v14, v14, v12
v_lshl_add_u32 v5, v8, 8, v14
v_and_b32 v7, 3, v0
v_add_u32 v7, 12, v7
v_lshlrev_b32 v7, 13, v7
s_and_b32 s51, s53, 15
s_mul_i32 s3, s51, 7282
s_lshr_b32 s3, s3, 16
s_mul_i32 s3, s3, 9
s_sub_u32 s80, s51, s3
s_lshl_b32 s80, s80, 7
s_add_u32 s81, s80, 128
s_cmp_eq_u32 s81, 1152
s_cselect_b32 s81, 0, s81
s_add_u32 s82, s81, 128
s_cmp_eq_u32 s82, 1152
s_cselect_b32 s82, 0, s82
s_add_u32 s83, s82, 128
s_cmp_eq_u32 s83, 1152
s_cselect_b32 s83, 0, s83
s_add_u32 s84, s83, 128
s_cmp_eq_u32 s84, 1152
s_cselect_b32 s84, 0, s84
s_add_u32 s85, s84, 128
s_cmp_eq_u32 s85, 1152
s_cselect_b32 s85, 0, s85
s_add_u32 s86, s85, 128
s_cmp_eq_u32 s86, 1152
s_cselect_b32 s86, 0, s86
s_add_u32 s87, s86, 128
s_cmp_eq_u32 s87, 1152
s_cselect_b32 s87, 0, s87
s_add_u32 s88, s87, 128
s_cmp_eq_u32 s88, 1152
s_cselect_b32 s88, 0, s88
s_and_b32 s89, s53, 1
s_mul_i32 s89, s89, 16384
v_lshrrev_b32 v112, 4, v0
v_bfe_u32 v113, v0, 3, 1
v_and_b32 v114, 7, v0
v_mul_u32_u24 v108, 512, v112
v_lshl_add_u32 v108, v113, 7, v108
v_lshl_add_u32 v108, v114, 4, v108
v_mul_u32_u24 v109, 1152, v114
v_lshl_add_u32 v109, v113, 3, v109
v_and_b32 v113, 1, v112
v_lshl_add_u32 v109, v113, 5, v109
v_lshrrev_b32 v113, 1, v112
v_lshl_add_u32 v109, v113, 4, v109
v_and_b32 v112, 1, v0
v_lshlrev_b32 v112, 4, v112
v_mov_b32 v113, 0x3f80
v_lshlrev_b32 v112, v112, v113
v_bfe_u32 v113, v0, 1, 3
v_cmp_eq_u32 vcc, 0, v113
s_nop 1
v_cndmask_b32 v100, 0, v112, vcc
v_cmp_eq_u32 vcc, 1, v113
s_nop 1
v_cndmask_b32 v101, 0, v112, vcc
v_cmp_eq_u32 vcc, 2, v113
s_nop 1
v_cndmask_b32 v102, 0, v112, vcc
v_cmp_eq_u32 vcc, 3, v113
s_nop 1
v_cndmask_b32 v103, 0, v112, vcc
v_cmp_eq_u32 vcc, 4, v113
s_nop 1
v_cndmask_b32 v104, 0, v112, vcc
v_cmp_eq_u32 vcc, 5, v113
s_nop 1
v_cndmask_b32 v105, 0, v112, vcc
v_cmp_eq_u32 vcc, 6, v113
s_nop 1
v_cndmask_b32 v106, 0, v112, vcc
v_cmp_eq_u32 vcc, 7, v113
s_nop 1
v_cndmask_b32 v107, 0, v112, vcc
s_lshl_b32 s3, s53, 4
v_mov_b32 v111, s3
v_and_b32 v114, 15, v0
v_mul_u32_u24 v114, 74240, v114
s_lshr_b32 s3, s50, 8
v_and_or_b32 v118, v0, 3, s3
v_cmp_eq_u32 vcc, s52, v118
v_xor_b32 v112, 1, v118
s_nop 0
v_cndmask_b32 v118, v118, v112, vcc
v_mul_u32_u24 v118, 74240, v118
v_and_b32 v112, 32, v0
v_lshl_add_u32 v118, v112, 1, v118
v_mov_b32 v119, 139264
v_lshrrev_b32 v112, 5, v0
v_bfe_u32 v113, v0, 4, 1
v_lshl_or_b32 v116, v113, 1, v112
v_and_b32 v113, 15, v0
v_lshl_add_u32 v116, v113, 2, v116
s_mul_i32 s3, s50, 9
s_add_u32 s3, s3, 98304
v_lshl_add_u32 v116, v116, 4, s3
s_lshl1_add_u32 s3, s50, 98304
v_lshl_add_u32 v117, v0, 4, s3
v_lshl_add_u32 v117, v112, 9, v117
v_bfe_u32 v113, v0, 2, 3
v_mul_u32_u24 v124, 1152, v113
v_lshl_add_u32 v124, v112, 7, v124
v_and_b32 v113, 3, v0
v_lshl_add_u32 v124, v113, 4, v124
s_lshr_b32 s3, s50, 8
s_sub_u32 s3, s52, s3
v_lshrrev_b32 v126, 4, v0
v_cmp_eq_u32 vcc, s3, v126
v_and_b32 v127, 1, v0
v_bfe_u32 v126, v0, 1, 4
v_cndmask_b32_e64 v125, v108, 2.0, vcc
v_lshlrev_b32 v126, 3, v126
v_lshl_add_u32 v127, v127, 8, v126
v_add_u32 v127, 143360, v127
s_lshr_b32 s3, s50, 9
v_add_u32 v112, s3, v112
s_lshr_b32 s3, s80, 7
v_cmp_gt_u32 vcc, s3, v112
v_add_u32 v113, 9, v112
s_nop 0
v_cndmask_b32 v112, v112, v113, vcc
v_lshl_add_u32 v126, v112, 9, v127
v_add_u32 v127, 4096, v127
s_waitcnt vmcnt(12)
s_add_u32 m0, s50, 16384
s_add_u32 s22, s72, 128
buffer_load_dwordx4 v3, s[36:39], s22 offen lds
s_add_u32 m0, s50, 20480
s_add_u32 s22, s72, 262272
buffer_load_dwordx4 v3, s[36:39], s22 offen lds
s_waitcnt vmcnt(12)
s_add_u32 m0, s50, 24576
s_add_u32 s22, s72, 256
buffer_load_dwordx4 v3, s[36:39], s22 offen lds
s_add_u32 m0, s50, 28672
s_add_u32 s22, s72, 262400
buffer_load_dwordx4 v3, s[36:39], s22 offen lds
s_waitcnt vmcnt(12)
s_add_u32 m0, s50, 32768
s_add_u32 s22, s72, 384
buffer_load_dwordx4 v3, s[36:39], s22 offen lds
s_add_u32 m0, s50, 36864
s_add_u32 s22, s72, 262528
buffer_load_dwordx4 v3, s[36:39], s22 offen lds
s_waitcnt vmcnt(12)
s_add_u32 m0, s50, 40960
s_add_u32 s22, s64, 0
buffer_load_dwordx4 v2, s[24:27], s22 offen lds
s_add_u32 m0, s50, 45056
s_add_u32 s22, s64, 36864
buffer_load_dwordx4 v2, s[24:27], s22 offen lds
s_waitcnt vmcnt(12)
s_barrier
s_add_u32 m0, s50, 49152
s_add_u32 s22, s73, 0
buffer_load_dwordx4 v3, s[36:39], s22 offen lds
s_add_u32 m0, s50, 53248
s_add_u32 s22, s73, 262144
buffer_load_dwordx4 v3, s[36:39], s22 offen lds
s_add_u32 m0, s50, 57344
s_add_u32 s22, s73, 128
buffer_load_dwordx4 v3, s[36:39], s22 offen lds
s_add_u32 m0, s50, 61440
s_add_u32 s22, s73, 262272
buffer_load_dwordx4 v3, s[36:39], s22 offen lds
s_add_u32 m0, s50, 65536
s_add_u32 s22, s73, 256
buffer_load_dwordx4 v3, s[36:39], s22 offen lds
s_add_u32 m0, s50, 69632
s_add_u32 s22, s73, 262400
buffer_load_dwordx4 v3, s[36:39], s22 offen lds
s_add_u32 m0, s50, 73728
s_add_u32 s22, s73, 384
buffer_load_dwordx4 v3, s[36:39], s22 offen lds
s_add_u32 m0, s50, 77824
s_add_u32 s22, s73, 262528
buffer_load_dwordx4 v3, s[36:39], s22 offen lds
s_add_u32 m0, s50, 81920
s_add_u32 s22, s65, 0
buffer_load_dwordx4 v2, s[24:27], s22 offen lds
s_add_u32 m0, s50, 86016
s_add_u32 s22, s65, 36864
buffer_load_dwordx4 v2, s[24:27], s22 offen lds
s_add_u32 m0, s50, 90112
s_add_u32 s22, s74, 0
buffer_load_dwordx4 v3, s[36:39], s22 offen lds
s_add_u32 m0, s50, 94208
s_add_u32 s22, s74, 262144
buffer_load_dwordx4 v3, s[36:39], s22 offen lds
s_waitcnt vmcnt(14)
s_barrier
s_add_u32 m0, s50, 98304
s_add_u32 s22, s74, 128
buffer_load_dwordx4 v3, s[36:39], s22 offen lds
s_add_u32 m0, s50, 102400
s_add_u32 s22, s74, 262272
buffer_load_dwordx4 v3, s[36:39], s22 offen lds
s_add_u32 m0, s50, 106496
s_add_u32 s22, s74, 256
buffer_load_dwordx4 v3, s[36:39], s22 offen lds
s_add_u32 m0, s50, 110592
s_add_u32 s22, s74, 262400
buffer_load_dwordx4 v3, s[36:39], s22 offen lds
s_add_u32 m0, s50, 114688
s_add_u32 s22, s74, 384
buffer_load_dwordx4 v3, s[36:39], s22 offen lds
s_add_u32 m0, s50, 118784
s_add_u32 s22, s74, 262528
buffer_load_dwordx4 v3, s[36:39], s22 offen lds
s_add_u32 m0, s50, 122880
s_add_u32 s22, s66, 0
buffer_load_dwordx4 v2, s[24:27], s22 offen lds
s_add_u32 m0, s50, 126976
s_add_u32 s22, s66, 36864
buffer_load_dwordx4 v2, s[24:27], s22 offen lds
s_add_u32 m0, s50, 131072
s_add_u32 s22, s75, 0
buffer_load_dwordx4 v3, s[36:39], s22 offen lds
s_add_u32 m0, s50, 135168
s_add_u32 s22, s75, 262144
buffer_load_dwordx4 v3, s[36:39], s22 offen lds
s_waitcnt vmcnt(14)
s_barrier
s_add_u32 m0, s50, 139264
s_add_u32 s22, s75, 128
buffer_load_dwordx4 v3, s[36:39], s22 offen lds
s_add_u32 m0, s50, 143360
s_add_u32 s22, s75, 262272
buffer_load_dwordx4 v3, s[36:39], s22 offen lds
s_add_u32 m0, s50, 147456
s_add_u32 s22, s75, 256
buffer_load_dwordx4 v3, s[36:39], s22 offen lds
s_add_u32 m0, s50, 151552
s_add_u32 s22, s75, 262400
buffer_load_dwordx4 v3, s[36:39], s22 offen lds
s_add_u32 m0, s50, 155648
s_add_u32 s22, s75, 384
buffer_load_dwordx4 v3, s[36:39], s22 offen lds
s_add_u32 m0, s50, 159744
s_add_u32 s22, s75, 262528
buffer_load_dwordx4 v3, s[36:39], s22 offen lds
s_add_u32 m0, s50, 0
s_add_u32 s22, s67, 0
buffer_load_dwordx4 v2, s[24:27], s22 offen lds
s_add_u32 m0, s50, 4096
s_add_u32 s22, s67, 36864
buffer_load_dwordx4 v2, s[24:27], s22 offen lds
s_add_u32 m0, s50, 8192
s_add_u32 s22, s76, 0
buffer_load_dwordx4 v3, s[36:39], s22 offen lds
s_add_u32 m0, s50, 12288
s_add_u32 s22, s76, 262144
buffer_load_dwordx4 v3, s[36:39], s22 offen lds
s_waitcnt vmcnt(14)
s_barrier
s_add_u32 m0, s50, 16384
s_add_u32 s22, s76, 128
buffer_load_dwordx4 v3, s[36:39], s22 offen lds
s_add_u32 m0, s50, 20480
s_add_u32 s22, s76, 262272
buffer_load_dwordx4 v3, s[36:39], s22 offen lds
s_add_u32 m0, s50, 24576
s_add_u32 s22, s76, 256
buffer_load_dwordx4 v3, s[36:39], s22 offen lds
s_add_u32 m0, s50, 28672
s_add_u32 s22, s76, 262400
buffer_load_dwordx4 v3, s[36:39], s22 offen lds
s_add_u32 m0, s50, 32768
s_add_u32 s22, s76, 384
buffer_load_dwordx4 v3, s[36:39], s22 offen lds
s_add_u32 m0, s50, 36864
s_add_u32 s22, s76, 262528
buffer_load_dwordx4 v3, s[36:39], s22 offen lds
s_add_u32 m0, s50, 40960
s_add_u32 s22, s68, 0
buffer_load_dwordx4 v2, s[24:27], s22 offen lds
s_add_u32 m0, s50, 45056
s_add_u32 s22, s68, 36864
buffer_load_dwordx4 v2, s[24:27], s22 offen lds
s_add_u32 m0, s50, 49152
s_add_u32 s22, s77, 0
buffer_load_dwordx4 v3, s[36:39], s22 offen lds
s_add_u32 m0, s50, 53248
s_add_u32 s22, s77, 262144
buffer_load_dwordx4 v3, s[36:39], s22 offen lds
s_waitcnt vmcnt(14)
s_barrier
s_add_u32 m0, s50, 57344
s_add_u32 s22, s77, 128
buffer_load_dwordx4 v3, s[36:39], s22 offen lds
s_add_u32 m0, s50, 61440
s_add_u32 s22, s77, 262272
buffer_load_dwordx4 v3, s[36:39], s22 offen lds
s_add_u32 m0, s50, 65536
s_add_u32 s22, s77, 256
buffer_load_dwordx4 v3, s[36:39], s22 offen lds
s_add_u32 m0, s50, 69632
s_add_u32 s22, s77, 262400
buffer_load_dwordx4 v3, s[36:39], s22 offen lds
s_add_u32 m0, s50, 73728
s_add_u32 s22, s77, 384
buffer_load_dwordx4 v3, s[36:39], s22 offen lds
s_add_u32 m0, s50, 77824
s_add_u32 s22, s77, 262528
buffer_load_dwordx4 v3, s[36:39], s22 offen lds
s_add_u32 m0, s50, 81920
s_add_u32 s22, s69, 0
buffer_load_dwordx4 v2, s[24:27], s22 offen lds
s_add_u32 m0, s50, 86016
s_add_u32 s22, s69, 36864
buffer_load_dwordx4 v2, s[24:27], s22 offen lds
s_add_u32 m0, s50, 90112
s_add_u32 s22, s78, 0
buffer_load_dwordx4 v3, s[36:39], s22 offen lds
s_add_u32 m0, s50, 94208
s_add_u32 s22, s78, 262144
buffer_load_dwordx4 v3, s[36:39], s22 offen lds
s_waitcnt vmcnt(14)
s_barrier
s_add_u32 m0, s50, 98304
s_add_u32 s22, s78, 128
buffer_load_dwordx4 v3, s[36:39], s22 offen lds
s_add_u32 m0, s50, 102400
s_add_u32 s22, s78, 262272
buffer_load_dwordx4 v3, s[36:39], s22 offen lds
s_add_u32 m0, s50, 106496
s_add_u32 s22, s78, 256
buffer_load_dwordx4 v3, s[36:39], s22 offen lds
s_add_u32 m0, s50, 110592
s_add_u32 s22, s78, 262400
buffer_load_dwordx4 v3, s[36:39], s22 offen lds
s_add_u32 m0, s50, 114688
s_add_u32 s22, s78, 384
buffer_load_dwordx4 v3, s[36:39], s22 offen lds
s_add_u32 m0, s50, 118784
s_add_u32 s22, s78, 262528
buffer_load_dwordx4 v3, s[36:39], s22 offen lds
s_add_u32 m0, s50, 122880
s_add_u32 s22, s70, 0
buffer_load_dwordx4 v2, s[24:27], s22 offen lds
s_add_u32 m0, s50, 126976
s_add_u32 s22, s70, 36864
buffer_load_dwordx4 v2, s[24:27], s22 offen lds
s_add_u32 m0, s50, 131072
s_add_u32 s22, s79, 0
buffer_load_dwordx4 v3, s[36:39], s22 offen lds
s_add_u32 m0, s50, 135168
s_add_u32 s22, s79, 262144
buffer_load_dwordx4 v3, s[36:39], s22 offen lds
s_waitcnt vmcnt(14)
s_barrier
s_add_u32 m0, s50, 139264
s_add_u32 s22, s79, 128
buffer_load_dwordx4 v3, s[36:39], s22 offen lds
s_add_u32 m0, s50, 143360
s_add_u32 s22, s79, 262272
buffer_load_dwordx4 v3, s[36:39], s22 offen lds
s_add_u32 m0, s50, 147456
s_add_u32 s22, s79, 256
buffer_load_dwordx4 v3, s[36:39], s22 offen lds
s_add_u32 m0, s50, 151552
s_add_u32 s22, s79, 262400
buffer_load_dwordx4 v3, s[36:39], s22 offen lds
s_add_u32 m0, s50, 155648
s_add_u32 s22, s79, 384
buffer_load_dwordx4 v3, s[36:39], s22 offen lds
s_add_u32 m0, s50, 159744
s_add_u32 s22, s79, 262528
buffer_load_dwordx4 v3, s[36:39], s22 offen lds
s_waitcnt vmcnt(10)
s_barrier
s_add_u32 m0, s50, 0
s_xor_b32 s22, s89, 0
buffer_load_dwordx4 v5, s[28:31], s22 offen lds
s_add_u32 m0, s50, 4096
s_xor_b32 s22, s89, 128
buffer_load_dwordx4 v5, s[28:31], s22 offen lds
s_add_u32 m0, s50, 8192
s_xor_b32 s22, s89, 8192
buffer_load_dwordx4 v5, s[28:31], s22 offen lds
s_add_u32 m0, s50, 12288
s_xor_b32 s22, s89, 8320
buffer_load_dwordx4 v5, s[28:31], s22 offen lds
s_add_u32 m0, s50, 16384
s_xor_b32 s22, s89, 0
buffer_load_dwordx4 v6, s[32:35], s22 offen lds
s_add_u32 m0, s50, 20480
s_xor_b32 s22, s89, 128
buffer_load_dwordx4 v6, s[32:35], s22 offen lds
s_add_u32 m0, s50, 24576
s_xor_b32 s22, s89, 16384
buffer_load_dwordx4 v5, s[28:31], s22 offen lds
s_add_u32 m0, s50, 28672
s_xor_b32 s22, s89, 16512
buffer_load_dwordx4 v5, s[28:31], s22 offen lds
s_add_u32 m0, s50, 32768
s_xor_b32 s22, s89, 8192
buffer_load_dwordx4 v6, s[32:35], s22 offen lds
s_add_u32 m0, s50, 36864
s_xor_b32 s22, s89, 8320
buffer_load_dwordx4 v6, s[32:35], s22 offen lds
s_waitcnt vmcnt(10)
s_barrier
s_add_u32 m0, s50, 40960
s_xor_b32 s22, s89, 24576
buffer_load_dwordx4 v5, s[28:31], s22 offen lds
s_add_u32 m0, s50, 45056
s_xor_b32 s22, s89, 24704
buffer_load_dwordx4 v5, s[28:31], s22 offen lds
s_waitcnt vmcnt(10)
s_barrier
s_add_u32 m0, s50, 49152
s_xor_b32 s22, s89, 16384
buffer_load_dwordx4 v6, s[32:35], s22 offen lds
s_add_u32 m0, s50, 53248
s_xor_b32 s22, s89, 16512
buffer_load_dwordx4 v6, s[32:35], s22 offen lds
s_add_u32 m0, s50, 57344
s_xor_b32 s22, s89, 32768
buffer_load_dwordx4 v5, s[28:31], s22 offen lds
s_add_u32 m0, s50, 61440
s_xor_b32 s22, s89, 32896
buffer_load_dwordx4 v5, s[28:31], s22 offen lds
s_waitcnt vmcnt(10)
s_barrier
s_add_u32 m0, s50, 65536
s_xor_b32 s22, s89, 24576
buffer_load_dwordx4 v6, s[32:35], s22 offen lds
s_add_u32 m0, s50, 69632
s_xor_b32 s22, s89, 24704
buffer_load_dwordx4 v6, s[32:35], s22 offen lds
s_add_u32 m0, s50, 73728
s_xor_b32 s22, s89, 40960
buffer_load_dwordx4 v5, s[28:31], s22 offen lds
s_add_u32 m0, s50, 77824
s_xor_b32 s22, s89, 41088
buffer_load_dwordx4 v5, s[28:31], s22 offen lds
s_waitcnt vmcnt(10)
s_barrier
s_add_u32 m0, s50, 81920
s_xor_b32 s22, s89, 32768
buffer_load_dwordx4 v6, s[32:35], s22 offen lds
s_add_u32 m0, s50, 86016
s_xor_b32 s22, s89, 32896
buffer_load_dwordx4 v6, s[32:35], s22 offen lds
s_add_u32 m0, s50, 90112
s_xor_b32 s22, s89, 49152
buffer_load_dwordx4 v5, s[28:31], s22 offen lds
s_add_u32 m0, s50, 94208
s_xor_b32 s22, s89, 49280
buffer_load_dwordx4 v5, s[28:31], s22 offen lds
s_waitcnt vmcnt(10)
s_barrier
s_add_u32 m0, s50, 98304
s_xor_b32 s22, s89, 40960
buffer_load_dwordx4 v6, s[32:35], s22 offen lds
s_add_u32 m0, s50, 102400
s_xor_b32 s22, s89, 41088
buffer_load_dwordx4 v6, s[32:35], s22 offen lds
s_add_u32 m0, s50, 106496
s_xor_b32 s22, s89, 57344
buffer_load_dwordx4 v5, s[28:31], s22 offen lds
s_add_u32 m0, s50, 110592
s_xor_b32 s22, s89, 57472
buffer_load_dwordx4 v5, s[28:31], s22 offen lds
s_waitcnt vmcnt(10)
s_barrier
s_add_u32 m0, s50, 114688
s_xor_b32 s22, s89, 49152
buffer_load_dwordx4 v6, s[32:35], s22 offen lds
s_add_u32 m0, s50, 118784
s_xor_b32 s22, s89, 49280
buffer_load_dwordx4 v6, s[32:35], s22 offen lds
s_add_u32 m0, s50, 122880
s_xor_b32 s22, s89, 65536
buffer_load_dwordx4 v5, s[28:31], s22 offen lds
s_add_u32 m0, s50, 126976
s_xor_b32 s22, s89, 65664
buffer_load_dwordx4 v5, s[28:31], s22 offen lds
s_waitcnt vmcnt(10)
s_barrier
s_add_u32 m0, s50, 131072
s_xor_b32 s22, s89, 57344
buffer_load_dwordx4 v6, s[32:35], s22 offen lds
s_add_u32 m0, s50, 135168
s_xor_b32 s22, s89, 57472
buffer_load_dwordx4 v6, s[32:35], s22 offen lds
s_add_u32 m0, s50, 139264
s_xor_b32 s22, s89, 73728
buffer_load_dwordx4 v5, s[28:31], s22 offen lds
s_add_u32 m0, s50, 143360
s_xor_b32 s22, s89, 73856
buffer_load_dwordx4 v5, s[28:31], s22 offen lds
s_mov_b32 s36, s16
s_mov_b32 s37, s17
s_mov_b32 s38, 256
s_mov_b32 s39, 0x20000
s_waitcnt vmcnt(10)
s_barrier
s_add_u32 m0, s50, 147456
s_xor_b32 s22, s89, 65536
buffer_load_dwordx4 v6, s[32:35], s22 offen lds
s_add_u32 m0, s50, 151552
s_xor_b32 s22, s89, 65664
buffer_load_dwordx4 v6, s[32:35], s22 offen lds
s_add_u32 m0, s50, 155648
s_xor_b32 s22, s89, 81920
buffer_load_dwordx4 v5, s[28:31], s22 offen lds
s_add_u32 m0, s50, 159744
s_xor_b32 s22, s89, 82048
buffer_load_dwordx4 v5, s[28:31], s22 offen lds
s_mul_i32 s3, s53, 1187840
s_add_u32 s44, s18, s3
s_addc_u32 s45, s19, 0
s_sub_u32 s46, 20971520, s3
s_mov_b32 s47, 0x20000
s_waitcnt vmcnt(10)
s_barrier
s_add_u32 m0, s50, 0
s_xor_b32 s22, s89, 73728
buffer_load_dwordx4 v6, s[32:35], s22 offen lds
s_add_u32 m0, s50, 4096
s_xor_b32 s22, s89, 73856
buffer_load_dwordx4 v6, s[32:35], s22 offen lds
s_add_u32 m0, s50, 8192
s_xor_b32 s22, s89, 90112
buffer_load_dwordx4 v5, s[28:31], s22 offen lds
s_add_u32 m0, s50, 12288
s_xor_b32 s22, s89, 90240
buffer_load_dwordx4 v5, s[28:31], s22 offen lds
s_add_u32 s24, s14, s55
s_addc_u32 s25, s15, 0
s_sub_u32 s26, 1179648, s55
s_mov_b32 s27, 0x20000
s_waitcnt vmcnt(10)
s_barrier
s_add_u32 m0, s50, 16384
s_xor_b32 s22, s89, 81920
buffer_load_dwordx4 v6, s[32:35], s22 offen lds
s_add_u32 m0, s50, 20480
s_xor_b32 s22, s89, 82048
buffer_load_dwordx4 v6, s[32:35], s22 offen lds
s_add_u32 m0, s50, 24576
s_xor_b32 s22, s89, 98304
buffer_load_dwordx4 v5, s[28:31], s22 offen lds
s_add_u32 m0, s50, 28672
s_xor_b32 s22, s89, 98432
buffer_load_dwordx4 v5, s[28:31], s22 offen lds
s_lshr_b32 s3, s50, 3
s_add_u32 s98, s80, s3
s_cmp_ge_u32 s98, 1152
s_cselect_b32 s3, 1152, 0
s_sub_u32 s98, s98, s3
s_waitcnt vmcnt(10)
s_barrier
s_add_u32 m0, s50, 32768
s_xor_b32 s22, s89, 90112
buffer_load_dwordx4 v6, s[32:35], s22 offen lds
s_add_u32 m0, s50, 36864
s_xor_b32 s22, s89, 90240
buffer_load_dwordx4 v6, s[32:35], s22 offen lds
s_add_u32 m0, s50, 40960
s_xor_b32 s22, s89, 106496
buffer_load_dwordx4 v5, s[28:31], s22 offen lds
s_add_u32 m0, s50, 45056
s_xor_b32 s22, s89, 106624
buffer_load_dwordx4 v5, s[28:31], s22 offen lds
s_mov_b32 s101, 0
s_mov_b32 s68, s52
s_mov_b32 s66, s98
s_lshr_b32 s69, s50, 10
s_waitcnt vmcnt(10)
s_barrier
s_add_u32 m0, s50, 49152
s_xor_b32 s22, s89, 98304
buffer_load_dwordx4 v6, s[32:35], s22 offen lds
s_add_u32 m0, s50, 53248
s_xor_b32 s22, s89, 98432
buffer_load_dwordx4 v6, s[32:35], s22 offen lds
s_add_u32 m0, s50, 57344
s_xor_b32 s22, s89, 114688
buffer_load_dwordx4 v5, s[28:31], s22 offen lds
s_add_u32 m0, s50, 61440
s_xor_b32 s22, s89, 114816
buffer_load_dwordx4 v5, s[28:31], s22 offen lds
s_mul_i32 s62, s68, 74240
s_lshr_b32 s3, s68, 3
s_and_b32 s99, s68, 3
s_lshl2_add_u32 s3, s3, s99
s_mul_i32 s3, s3, 9216
s_bfe_u32 s99, s68, 0x10002
s_lshl_b32 s99, s99, 6
s_add_u32 s99, s99, s3
s_lshr_b32 s3, s68, 2
s_lshl_b32 s3, s3, 7
s_add_u32 s71, s3, 73728
s_waitcnt vmcnt(10)
s_barrier
s_add_u32 m0, s50, 65536
s_xor_b32 s22, s89, 106496
buffer_load_dwordx4 v6, s[32:35], s22 offen lds
s_add_u32 m0, s50, 69632
s_xor_b32 s22, s89, 106624
buffer_load_dwordx4 v6, s[32:35], s22 offen lds
s_add_u32 m0, s50, 73728
s_xor_b32 s22, s89, 122880
buffer_load_dwordx4 v5, s[28:31], s22 offen lds
s_add_u32 m0, s50, 77824
s_xor_b32 s22, s89, 123008
buffer_load_dwordx4 v5, s[28:31], s22 offen lds
s_waitcnt vmcnt(10)
s_barrier
s_add_u32 m0, s50, 81920
s_xor_b32 s22, s89, 114688
buffer_load_dwordx4 v6, s[32:35], s22 offen lds
s_add_u32 m0, s50, 86016
s_xor_b32 s22, s89, 114816
buffer_load_dwordx4 v6, s[32:35], s22 offen lds
s_add_u32 m0, s50, 90112
s_xor_b32 s22, s89, 122880
buffer_load_dwordx4 v6, s[32:35], s22 offen lds
s_add_u32 m0, s50, 94208
s_xor_b32 s22, s89, 123008
buffer_load_dwordx4 v6, s[32:35], s22 offen lds
s_add_u32 m0, s50, 131072
s_add_u32 s22, s80, 0
buffer_load_dwordx4 v4, s[40:43], s22 offen lds
s_add_u32 m0, s50, 135168
s_add_u32 s22, s80, 36864
buffer_load_dwordx4 v4, s[40:43], s22 offen lds
buffer_load_dword v110, v111, s[36:39], 0 offen sc1
s_waitcnt vmcnt(13)
s_barrier
s_add_u32 m0, s50, 139264
s_add_u32 s22, s80, 73728
buffer_load_dwordx4 v4, s[40:43], s22 offen lds
s_add_u32 m0, s50, 143360
s_add_u32 s22, s80, 110592
buffer_load_dwordx4 v4, s[40:43], s22 offen lds
s_add_u32 m0, s50, 147456
s_add_u32 s22, s80, 147456
buffer_load_dwordx4 v4, s[40:43], s22 offen lds
s_add_u32 m0, s50, 151552
s_add_u32 s22, s80, 184320
buffer_load_dwordx4 v4, s[40:43], s22 offen lds
s_add_u32 m0, s50, 155648
s_add_u32 s22, s80, 221184
buffer_load_dwordx4 v4, s[40:43], s22 offen lds
s_add_u32 m0, s50, 159744
s_add_u32 s22, s80, 258048
buffer_load_dwordx4 v4, s[40:43], s22 offen lds
s_waitcnt vmcnt(15)
s_barrier
s_add_u32 m0, s50, 0
s_add_u32 s22, s81, 0
buffer_load_dwordx4 v4, s[40:43], s22 offen lds
s_add_u32 m0, s50, 4096
s_add_u32 s22, s81, 36864
buffer_load_dwordx4 v4, s[40:43], s22 offen lds
s_add_u32 m0, s50, 8192
s_add_u32 s22, s81, 73728
buffer_load_dwordx4 v4, s[40:43], s22 offen lds
s_add_u32 m0, s50, 12288
s_add_u32 s22, s81, 110592
buffer_load_dwordx4 v4, s[40:43], s22 offen lds
s_add_u32 m0, s50, 16384
s_add_u32 s22, s81, 147456
buffer_load_dwordx4 v4, s[40:43], s22 offen lds
s_add_u32 m0, s50, 20480
s_add_u32 s22, s81, 184320
buffer_load_dwordx4 v4, s[40:43], s22 offen lds
s_waitcnt vmcnt(17)
s_barrier
s_add_u32 m0, s50, 24576
s_add_u32 s22, s81, 221184
buffer_load_dwordx4 v4, s[40:43], s22 offen lds
s_add_u32 m0, s50, 28672
s_add_u32 s22, s81, 258048
buffer_load_dwordx4 v4, s[40:43], s22 offen lds
s_add_u32 m0, s50, 32768
s_add_u32 s22, s82, 0
buffer_load_dwordx4 v4, s[40:43], s22 offen lds
s_add_u32 m0, s50, 36864
s_add_u32 s22, s82, 36864
buffer_load_dwordx4 v4, s[40:43], s22 offen lds
s_add_u32 m0, s50, 40960
s_add_u32 s22, s82, 73728
buffer_load_dwordx4 v4, s[40:43], s22 offen lds
s_add_u32 m0, s50, 45056
s_add_u32 s22, s82, 110592
buffer_load_dwordx4 v4, s[40:43], s22 offen lds
s_waitcnt vmcnt(12)
s_barrier
s_add_u32 m0, s50, 49152
s_add_u32 s22, s82, 147456
buffer_load_dwordx4 v4, s[40:43], s22 offen lds
s_add_u32 m0, s50, 53248
s_add_u32 s22, s82, 184320
buffer_load_dwordx4 v4, s[40:43], s22 offen lds
s_add_u32 m0, s50, 57344
s_add_u32 s22, s82, 221184
buffer_load_dwordx4 v4, s[40:43], s22 offen lds
s_add_u32 m0, s50, 61440
s_add_u32 s22, s82, 258048
buffer_load_dwordx4 v4, s[40:43], s22 offen lds
s_add_u32 m0, s50, 65536
s_add_u32 s22, s83, 0
buffer_load_dwordx4 v4, s[40:43], s22 offen lds
s_add_u32 m0, s50, 69632
s_add_u32 s22, s83, 36864
buffer_load_dwordx4 v4, s[40:43], s22 offen lds
s_add_u32 m0, s50, 73728
s_add_u32 s22, s83, 73728
buffer_load_dwordx4 v4, s[40:43], s22 offen lds
s_add_u32 m0, s50, 77824
s_add_u32 s22, s83, 110592
buffer_load_dwordx4 v4, s[40:43], s22 offen lds
s_barrier
ds_read_b32 v15, v7
s_waitcnt lgkmcnt(0)
v_cmp_eq_u32 vcc, -1, v15
s_nop 1
s_and_b64 vcc, vcc, s[48:49]
s_cbranch_scc1 L_redo_l
s_add_u32 m0, s50, 81920
s_add_u32 s22, s83, 147456
buffer_load_dwordx4 v4, s[40:43], s22 offen lds
s_add_u32 m0, s50, 86016
s_add_u32 s22, s83, 184320
buffer_load_dwordx4 v4, s[40:43], s22 offen lds
s_add_u32 m0, s50, 90112
s_add_u32 s22, s83, 221184
buffer_load_dwordx4 v4, s[40:43], s22 offen lds
s_add_u32 m0, s50, 94208
s_add_u32 s22, s83, 258048
buffer_load_dwordx4 v4, s[40:43], s22 offen lds
s_barrier
s_add_u32 m0, s50, 98304
s_add_u32 s22, s84, 0
buffer_load_dwordx4 v4, s[40:43], s22 offen lds
s_add_u32 m0, s50, 102400
s_add_u32 s22, s84, 36864
buffer_load_dwordx4 v4, s[40:43], s22 offen lds
s_add_u32 m0, s50, 106496
s_add_u32 s22, s84, 73728
buffer_load_dwordx4 v4, s[40:43], s22 offen lds
s_add_u32 m0, s50, 110592
s_add_u32 s22, s84, 110592
buffer_load_dwordx4 v4, s[40:43], s22 offen lds
s_add_u32 m0, s50, 114688
s_add_u32 s22, s84, 147456
buffer_load_dwordx4 v4, s[40:43], s22 offen lds
s_add_u32 m0, s50, 118784
s_add_u32 s22, s84, 184320
buffer_load_dwordx4 v4, s[40:43], s22 offen lds
s_add_u32 m0, s50, 122880
s_add_u32 s22, s84, 221184
buffer_load_dwordx4 v4, s[40:43], s22 offen lds
s_add_u32 m0, s50, 126976
s_add_u32 s22, s84, 258048
buffer_load_dwordx4 v4, s[40:43], s22 offen lds
s_waitcnt vmcnt(24)
s_barrier
s_add_u32 m0, s50, 131072
s_add_u32 s22, s85, 0
buffer_load_dwordx4 v4, s[40:43], s22 offen lds
s_add_u32 m0, s50, 135168
s_add_u32 s22, s85, 36864
buffer_load_dwordx4 v4, s[40:43], s22 offen lds
s_waitcnt vmcnt(18)
s_barrier
s_add_u32 m0, s50, 139264
s_add_u32 s22, s85, 73728
buffer_load_dwordx4 v4, s[40:43], s22 offen lds
s_add_u32 m0, s50, 143360
s_add_u32 s22, s85, 110592
buffer_load_dwordx4 v4, s[40:43], s22 offen lds
s_add_u32 m0, s50, 147456
s_add_u32 s22, s85, 147456
buffer_load_dwordx4 v4, s[40:43], s22 offen lds
s_add_u32 m0, s50, 151552
s_add_u32 s22, s85, 184320
buffer_load_dwordx4 v4, s[40:43], s22 offen lds
s_add_u32 m0, s50, 155648
s_add_u32 s22, s85, 221184
buffer_load_dwordx4 v4, s[40:43], s22 offen lds
s_add_u32 m0, s50, 159744
s_add_u32 s22, s85, 258048
buffer_load_dwordx4 v4, s[40:43], s22 offen lds
s_add_u32 m0, s50, 0
s_add_u32 s22, s86, 0
buffer_load_dwordx4 v4, s[40:43], s22 offen lds
s_add_u32 m0, s50, 4096
s_add_u32 s22, s86, 36864
buffer_load_dwordx4 v4, s[40:43], s22 offen lds
s_waitcnt vmcnt(18)
s_barrier
s_add_u32 m0, s50, 8192
s_add_u32 s22, s86, 73728
buffer_load_dwordx4 v4, s[40:43], s22 offen lds
s_add_u32 m0, s50, 12288
s_add_u32 s22, s86, 110592
buffer_load_dwordx4 v4, s[40:43], s22 offen lds
s_add_u32 m0, s50, 16384
s_add_u32 s22, s86, 147456
buffer_load_dwordx4 v4, s[40:43], s22 offen lds
s_add_u32 m0, s50, 20480
s_add_u32 s22, s86, 184320
buffer_load_dwordx4 v4, s[40:43], s22 offen lds
s_add_u32 m0, s50, 24576
s_add_u32 s22, s86, 221184
buffer_load_dwordx4 v4, s[40:43], s22 offen lds
s_add_u32 m0, s50, 28672
s_add_u32 s22, s86, 258048
buffer_load_dwordx4 v4, s[40:43], s22 offen lds
s_add_u32 m0, s50, 32768
s_add_u32 s22, s87, 0
buffer_load_dwordx4 v4, s[40:43], s22 offen lds
s_add_u32 m0, s50, 36864
s_add_u32 s22, s87, 36864
buffer_load_dwordx4 v4, s[40:43], s22 offen lds
s_waitcnt vmcnt(18)
s_barrier
s_add_u32 m0, s50, 40960
s_add_u32 s22, s87, 73728
buffer_load_dwordx4 v4, s[40:43], s22 offen lds
s_add_u32 m0, s50, 45056
s_add_u32 s22, s87, 110592
buffer_load_dwordx4 v4, s[40:43], s22 offen lds
s_add_u32 m0, s50, 49152
s_add_u32 s22, s87, 147456
buffer_load_dwordx4 v4, s[40:43], s22 offen lds
s_add_u32 m0, s50, 53248
s_add_u32 s22, s87, 184320
buffer_load_dwordx4 v4, s[40:43], s22 offen lds
s_add_u32 m0, s50, 57344
s_add_u32 s22, s87, 221184
buffer_load_dwordx4 v4, s[40:43], s22 offen lds
s_add_u32 m0, s50, 61440
s_add_u32 s22, s87, 258048
buffer_load_dwordx4 v4, s[40:43], s22 offen lds
s_add_u32 m0, s50, 65536
s_add_u32 s22, s88, 0
buffer_load_dwordx4 v4, s[40:43], s22 offen lds
s_add_u32 m0, s50, 69632
s_add_u32 s22, s88, 36864
buffer_load_dwordx4 v4, s[40:43], s22 offen lds
s_waitcnt vmcnt(18)
s_barrier
s_add_u32 m0, s50, 73728
s_add_u32 s22, s88, 73728
buffer_load_dwordx4 v4, s[40:43], s22 offen lds
s_add_u32 m0, s50, 77824
s_add_u32 s22, s88, 110592
buffer_load_dwordx4 v4, s[40:43], s22 offen lds
s_add_u32 m0, s50, 81920
s_add_u32 s22, s88, 147456
buffer_load_dwordx4 v4, s[40:43], s22 offen lds
s_add_u32 m0, s50, 86016
s_add_u32 s22, s88, 184320
buffer_load_dwordx4 v4, s[40:43], s22 offen lds
s_add_u32 m0, s50, 90112
s_add_u32 s22, s88, 221184
buffer_load_dwordx4 v4, s[40:43], s22 offen lds
s_add_u32 m0, s50, 94208
s_add_u32 s22, s88, 258048
buffer_load_dwordx4 v4, s[40:43], s22 offen lds
s_waitcnt vmcnt(16)
s_barrier
s_waitcnt vmcnt(8)
s_barrier
s_cmp_lg_u32 s50, 0
s_cbranch_scc1 L_nbc
ds_write_b32 v119, v110
s_waitcnt lgkmcnt(0)
L_nbc:
s_waitcnt vmcnt(0)
s_barrier
ds_read_b32 v110, v119
s_waitcnt lgkmcnt(0)
v_readfirstlane_b32 s67, v110
s_cmp_eq_u32 s67, 16
s_mov_b32 s67, 0
s_cbranch_scc0 L_cslow
s_lshl1_add_u32 s76, s50, s62
s_lshr_b32 s72, s50, 2
s_add_u32 s72, s72, s99
L_q00:
buffer_load_dword v120, v118, s[44:47], s71 offen sc1
s_waitcnt vmcnt(0)
v_cmp_eq_u32 vcc, 0, v120
s_add_u32 s101, s101, 1
s_nop 0
s_min_u32 s3, vcc_lo, vcc_hi
s_cmp_eq_u32 s3, 0
s_cbranch_scc1 L_q10
s_sleep 4
s_cmp_gt_u32 s101, 0x20000
s_cbranch_scc0 L_q00
L_q10:
s_lshl_b32 s3, s80, 6
s_add_u32 s3, s3, s76
buffer_load_dwordx4 v[128:131], v125, s[44:47], s3 offen offset:0 sc1
buffer_load_dwordx4 v[132:135], v125, s[44:47], s3 offen offset:256 sc1
s_lshl_b32 s3, s81, 6
s_add_u32 s3, s3, s76
buffer_load_dwordx4 v[136:139], v125, s[44:47], s3 offen offset:0 sc1
buffer_load_dwordx4 v[140:143], v125, s[44:47], s3 offen offset:256 sc1
s_lshl_b32 s3, s82, 6
s_add_u32 s3, s3, s76
buffer_load_dwordx4 v[144:147], v125, s[44:47], s3 offen offset:0 sc1
buffer_load_dwordx4 v[148:151], v125, s[44:47], s3 offen offset:256 sc1
s_lshl_b32 s3, s83, 6
s_add_u32 s3, s3, s76
buffer_load_dwordx4 v[152:155], v125, s[44:47], s3 offen offset:0 sc1
buffer_load_dwordx4 v[156:159], v125, s[44:47], s3 offen offset:256 sc1
s_cmp_eq_u32 vcc_hi, 0
s_cbranch_scc1 L_q11
s_waitcnt vmcnt(0)
L_q01:
buffer_load_dword v120, v118, s[44:47], s71 offen sc1
s_waitcnt vmcnt(0)
v_cmp_eq_u32 vcc, 0, v120
s_add_u32 s101, s101, 1
s_nop 0
s_cmp_eq_u32 vcc_hi, 0
s_cbranch_scc1 L_q11
s_sleep 8
s_cmp_gt_u32 s101, 0x20000
s_cbranch_scc0 L_q01
L_q11:
s_lshl_b32 s3, s84, 6
s_add_u32 s3, s3, s76
buffer_load_dwordx4 v[160:163], v125, s[44:47], s3 offen offset:0 sc1
buffer_load_dwordx4 v[164:167], v125, s[44:47], s3 offen offset:256 sc1
s_lshl_b32 s3, s85, 6
s_add_u32 s3, s3, s76
buffer_load_dwordx4 v[168:171], v125, s[44:47], s3 offen offset:0 sc1
buffer_load_dwordx4 v[172:175], v125, s[44:47], s3 offen offset:256 sc1
s_lshl_b32 s3, s86, 6
s_add_u32 s3, s3, s76
buffer_load_dwordx4 v[176:179], v125, s[44:47], s3 offen offset:0 sc1
buffer_load_dwordx4 v[180:183], v125, s[44:47], s3 offen offset:256 sc1
s_lshl_b32 s3, s87, 6
s_add_u32 s3, s3, s76
buffer_load_dwordx4 v[184:187], v125, s[44:47], s3 offen offset:0 sc1
buffer_load_dwordx4 v[188:191], v125, s[44:47], s3 offen offset:256 sc1
s_lshl_b32 s3, s88, 6
s_add_u32 s3, s3, s76
buffer_load_dwordx4 v[192:195], v125, s[44:47], s3 offen offset:0 sc1
buffer_load_dwordx4 v[196:199], v125, s[44:47], s3 offen offset:256 sc1
v_lshl_add_u32 v24, s80, 3, v116
v_lshl_add_u32 v25, s81, 3, v116
v_lshl_add_u32 v26, s82, 3, v116
v_lshl_add_u32 v27, s83, 3, v116
v_lshl_add_u32 v28, s84, 3, v116
v_lshl_add_u32 v29, s85, 3, v116
v_lshl_add_u32 v30, s86, 3, v116
v_lshl_add_u32 v31, s87, 3, v116
v_lshl_add_u32 v32, s88, 3, v116
s_waitcnt vmcnt(17)
v_mfma_f32_16x16x32_bf16 v[64:67], v[100:103], v[128:131], 0
s_waitcnt vmcnt(16)
v_mfma_f32_16x16x32_bf16 v[64:67], v[104:107], v[132:135], v[64:67]
s_waitcnt vmcnt(15)
v_mfma_f32_16x16x32_bf16 v[68:71], v[100:103], v[136:139], 0
s_waitcnt vmcnt(14)
v_mfma_f32_16x16x32_bf16 v[68:71], v[104:107], v[140:143], v[68:71]
s_waitcnt vmcnt(13)
v_mfma_f32_16x16x32_bf16 v[72:75], v[100:103], v[144:147], 0
s_waitcnt vmcnt(12)
v_mfma_f32_16x16x32_bf16 v[72:75], v[104:107], v[148:151], v[72:75]
ds_write_b128 v24, v[64:67]
s_waitcnt vmcnt(11)
v_mfma_f32_16x16x32_bf16 v[76:79], v[100:103], v[152:155], 0
s_waitcnt vmcnt(10)
v_mfma_f32_16x16x32_bf16 v[76:79], v[104:107], v[156:159], v[76:79]
ds_write_b128 v25, v[68:71]
s_waitcnt vmcnt(9)
v_mfma_f32_16x16x32_bf16 v[80:83], v[100:103], v[160:163], 0
s_waitcnt vmcnt(8)
v_mfma_f32_16x16x32_bf16 v[80:83], v[104:107], v[164:167], v[80:83]
ds_write_b128 v26, v[72:75]
s_waitcnt vmcnt(7)
v_mfma_f32_16x16x32_bf16 v[84:87], v[100:103], v[168:171], 0
s_waitcnt vmcnt(6)
v_mfma_f32_16x16x32_bf16 v[84:87], v[104:107], v[172:175], v[84:87]
ds_write_b128 v27, v[76:79]
s_waitcnt vmcnt(5)
v_mfma_f32_16x16x32_bf16 v[88:91], v[100:103], v[176:179], 0
s_waitcnt vmcnt(4)
v_mfma_f32_16x16x32_bf16 v[88:91], v[104:107], v[180:183], v[88:91]
ds_write_b128 v28, v[80:83]
s_waitcnt vmcnt(3)
v_mfma_f32_16x16x32_bf16 v[92:95], v[100:103], v[184:187], 0
s_waitcnt vmcnt(2)
v_mfma_f32_16x16x32_bf16 v[92:95], v[104:107], v[188:191], v[92:95]
ds_write_b128 v29, v[84:87]
s_waitcnt vmcnt(1)
v_mfma_f32_16x16x32_bf16 v[96:99], v[100:103], v[192:195], 0
s_waitcnt vmcnt(0)
v_mfma_f32_16x16x32_bf16 v[96:99], v[104:107], v[196:199], v[96:99]
ds_write_b128 v30, v[88:91]
s_nop 3
ds_write_b128 v31, v[92:95]
s_nop 2
ds_write_b128 v32, v[96:99]
s_waitcnt lgkmcnt(0)
s_barrier
s_cmp_lg_u32 s69, 0
ds_read2_b64 v[192:195], v126 offset1:16
ds_read_b128 v[128:131], v117 offset:0
ds_read_b128 v[132:135], v117 offset:512
ds_read_b128 v[136:139], v117 offset:9216
ds_read_b128 v[140:143], v117 offset:9728
ds_read_b128 v[144:147], v117 offset:18432
ds_read_b128 v[148:151], v117 offset:18944
ds_read_b128 v[152:155], v117 offset:27648
ds_read_b128 v[156:159], v117 offset:28160
s_cbranch_scc1 L_q2
ds_read2_b64 v[196:199], v127 offset1:16
ds_read_b128 v[160:163], v117 offset:8192
ds_read_b128 v[164:167], v117 offset:8704
ds_read_b128 v[168:171], v117 offset:17408
ds_read_b128 v[172:175], v117 offset:17920
ds_read_b128 v[176:179], v117 offset:26624
ds_read_b128 v[180:183], v117 offset:27136
ds_read_b128 v[184:187], v117 offset:35840
ds_read_b128 v[188:191], v117 offset:36352
L_q2:
s_waitcnt lgkmcnt(8)
v_lshlrev_b32 v200, 16, v192
v_and_b32 v201, 0xffff0000, v192
v_lshlrev_b32 v202, 16, v193
v_and_b32 v203, 0xffff0000, v193
v_lshlrev_b32 v204, 16, v194
v_and_b32 v205, 0xffff0000, v194
v_lshlrev_b32 v206, 16, v195
v_and_b32 v207, 0xffff0000, v195
s_waitcnt lgkmcnt(6)
v_pk_add_f32 v[128:129], v[128:129], v[200:201]
v_pk_add_f32 v[130:131], v[130:131], v[202:203]
v_pk_add_f32 v[132:133], v[132:133], v[204:205]
v_pk_add_f32 v[134:135], v[134:135], v[206:207]
s_waitcnt lgkmcnt(4)
v_pk_add_f32 v[128:129], v[128:129], v[136:137]
v_pk_add_f32 v[130:131], v[130:131], v[138:139]
v_pk_add_f32 v[132:133], v[132:133], v[140:141]
v_pk_add_f32 v[134:135], v[134:135], v[142:143]
s_waitcnt lgkmcnt(0)
v_pk_add_f32 v[144:145], v[144:145], v[152:153]
v_pk_add_f32 v[146:147], v[146:147], v[154:155]
v_pk_add_f32 v[148:149], v[148:149], v[156:157]
v_pk_add_f32 v[150:151], v[150:151], v[158:159]
v_pk_add_f32 v[128:129], v[128:129], v[144:145]
v_pk_add_f32 v[130:131], v[130:131], v[146:147]
v_pk_add_f32 v[132:133], v[132:133], v[148:149]
v_pk_add_f32 v[134:135], v[134:135], v[150:151]
v_cvt_pk_bf16_f32 v128, v128, v129
v_cvt_pk_bf16_f32 v129, v130, v131
v_cvt_pk_bf16_f32 v130, v132, v133
v_cvt_pk_bf16_f32 v131, v134, v135
buffer_store_dwordx4 v[128:131], v124, s[24:27], s72 offen offset:0 sc1
s_cbranch_scc1 L_q3
s_mov_b32 exec_hi, 0
v_lshlrev_b32 v200, 16, v196
v_and_b32 v201, 0xffff0000, v196
v_lshlrev_b32 v202, 16, v197
v_and_b32 v203, 0xffff0000, v197
v_lshlrev_b32 v204, 16, v198
v_and_b32 v205, 0xffff0000, v198
v_lshlrev_b32 v206, 16, v199
v_and_b32 v207, 0xffff0000, v199
v_pk_add_f32 v[160:161], v[160:161], v[200:201]
v_pk_add_f32 v[162:163], v[162:163], v[202:203]
v_pk_add_f32 v[164:165], v[164:165], v[204:205]
v_pk_add_f32 v[166:167], v[166:167], v[206:207]
v_pk_add_f32 v[160:161], v[160:161], v[168:169]
v_pk_add_f32 v[162:163], v[162:163], v[170:171]
v_pk_add_f32 v[164:165], v[164:165], v[172:173]
v_pk_add_f32 v[166:167], v[166:167], v[174:175]
v_pk_add_f32 v[176:177], v[176:177], v[184:185]
v_pk_add_f32 v[178:179], v[178:179], v[186:187]
v_pk_add_f32 v[180:181], v[180:181], v[188:189]
v_pk_add_f32 v[182:183], v[182:183], v[190:191]
v_pk_add_f32 v[160:161], v[160:161], v[176:177]
v_pk_add_f32 v[162:163], v[162:163], v[178:179]
v_pk_add_f32 v[164:165], v[164:165], v[180:181]
v_pk_add_f32 v[166:167], v[166:167], v[182:183]
v_cvt_pk_bf16_f32 v160, v160, v161
v_cvt_pk_bf16_f32 v161, v162, v163
v_cvt_pk_bf16_f32 v162, v164, v165
v_cvt_pk_bf16_f32 v163, v166, v167
buffer_store_dwordx4 v[160:163], v124, s[24:27], s72 offen offset:1024 sc1
s_mov_b32 exec_hi, -1
L_q3:
L_cdone:
s_endpgm
L_redo_l:
s_waitcnt vmcnt(0)
s_mov_b64 s[48:49], 0
s_barrier
s_branch L_load0
L_compute:
s_sub_u32 s66, s66, L_pc-standalone__gqa_block_cached__near_ridge_kernel
s_subb_u32 s67, s67, 0
s_lshr_b32 s3, s2, 3
s_and_b32 s3, s3, 3
s_cmp_eq_u32 s3, s20
s_cbranch_scc0 L_nocpf
s_lshl_b32 s3, s3, 13
v_lshl_add_u32 v252, v0, 7, s3
v_min_u32 v252, L_redo_c-standalone__gqa_block_cached__near_ridge_kernel, v252
v_mov_b32 v253, s67
v_add_co_u32 v252, vcc, s66, v252
s_nop 1
v_addc_co_u32 v253, vcc, 0, v253, vcc
global_load_dword v39, v[252:253], off
s_add_u32 s3, s3, 32768
v_lshl_add_u32 v250, v0, 7, s3
v_min_u32 v250, L_redo_c-standalone__gqa_block_cached__near_ridge_kernel, v250
v_mov_b32 v251, 0
v_lshl_add_u64 v[250:251], v[250:251], 0, s[66:67]
global_load_dword v39, v[250:251], off
L_nocpf:
s_mul_i32 s57, s52, 294912
s_lshl4_add_u32 s58, s54, s52
s_lshl_b32 s58, s58, 17
s_mul_i32 s59, s53, 1187840
s_add_u32 s59, s59, s56
v_mov_b32 v1, 0
v_mov_b32 v38, 0
s_waitcnt lgkmcnt(0)
s_add_u32 s44, s18, s59
s_addc_u32 s45, s19, 0
s_sub_u32 s46, 268435456, s59
s_mov_b32 s47, 0x20000
s_add_u32 s28, s6, s58
s_addc_u32 s29, s7, 0
s_sub_u32 s30, 16777216, s58
s_mov_b32 s31, 0x20000
s_mov_b32 s21, 0x3e0293ee
s_and_b32 s51, s20, 1
s_lshr_b32 s62, s20, 1
s_add_u32 s32, s8, s58
s_addc_u32 s33, s9, 0
s_sub_u32 s34, 16777216, s58
s_mov_b32 s35, 0x20000
s_add_u32 s40, s12, s57
s_addc_u32 s41, s13, 0
s_sub_u32 s42, 4718592, s57
s_mov_b32 s43, 0x20000
s_cmp_eq_u32 s20, 3
s_cbranch_scc0 L_notlb
v_and_b32 v252, 1, v0
v_mul_u32_u24 v251, 294784, v252
v_mul_u32_u24 v252, 1179648, v252
v_mov_b32 v253, 0
buffer_load_dword v39, v253, s[28:31], 0 offen
buffer_load_dword v39, v253, s[32:35], 0 offen
buffer_load_dword v39, v251, s[40:43], 0 offen
buffer_load_dword v39, v252, s[44:47], 0 offen
L_notlb:
s_and_b32 s63, s53, 15
s_mul_i32 s3, s63, 7282
s_lshr_b32 s3, s3, 16
s_mul_i32 s3, s3, 9
s_sub_u32 s65, s63, s3
s_lshl_b32 s65, s65, 7
s_lshl_b32 s65, s65, 6
s_mov_b32 s24, s16
s_mov_b32 s25, s17
s_mov_b32 s26, 256
s_mov_b32 s27, 0x20000
s_lshl_b32 s63, s20, 11
v_lshl_add_u32 v2, v0, 4, s63
s_lshl_b32 s63, s53, 4
v_lshl_add_u32 v6, v2, 4, s63
v_mov_b32 v7, 1
v_mov_b32 v40, -1
v_mov_b32 v41, -1
v_mov_b32 v42, -1
v_mov_b32 v43, -1
s_lshl_b32 s3, s20, 7
s_add_u32 s3, s3, s59
s_add_u32 s3, s3, 73728
s_mul_i32 s63, s52, 73728
s_add_u32 s3, s3, s63
s_add_u32 s32, s18, s3
s_addc_u32 s33, s19, 0
s_sub_u32 s34, 0, s3
s_mov_b32 s35, 0x20000
s_mov_b32 s34, 128
v_lshlrev_b32 v4, 7, v0
v_mov_b32 v3, 0
v_lshlrev_b32 v160, 4, v0
v_mov_b32 v164, 0
v_mov_b32 v165, 0
v_mov_b32 v166, 0
v_mov_b32 v167, 0
L_restart:
v_lshrrev_b32 v200, 4, v0
v_and_b32 v201, 15, v0
v_bfe_u32 v202, v0, 2, 2
v_and_b32 v203, 3, v0
v_lshrrev_b32 v204, 5, v0
v_and_b32 v205, 1, v200
v_lshrrev_b32 v206, 1, v202
v_lshl_or_b32 v207, v205, 1, v206
s_lshl_b32 s63, s62, 12
v_lshrrev_b32 v208, 1, v201
v_xor_b32 v208, v208, v200
v_lshlrev_b32 v208, 4, v208
v_lshl_add_u32 v208, v201, 7, v208
v_add_u32 v136, s63, v208
v_xor_b32 v137, 64, v136
s_lshl_b32 s63, s51, 14
v_lshl_add_u32 v208, v200, 3, v202
v_lshlrev_b32 v208, 7, v208
v_lshl_add_u32 v208, v203, 3, v208
v_lshl_add_u32 v208, v207, 5, v208
v_add_u32 v138, s63, v208
v_xor_b32 v139, 32, v138
v_xor_b32 v140, 64, v138
v_xor_b32 v141, 96, v138
v_add_u32 v154, 122880, v136
v_add_u32 v155, 122880, v137
v_add_u32 v156, 122880, v138
v_add_u32 v157, 122880, v139
v_add_u32 v158, 122880, v140
v_add_u32 v159, 122880, v141
v_add_u32 v142, 40960, v136
v_add_u32 v143, 40960, v137
v_add_u32 v144, 40960, v138
v_add_u32 v145, 40960, v139
v_add_u32 v146, 40960, v140
v_add_u32 v147, 40960, v141
v_add_u32 v148, 81920, v136
v_add_u32 v149, 81920, v137
v_add_u32 v150, 81920, v138
v_add_u32 v151, 81920, v139
v_add_u32 v152, 81920, v140
v_add_u32 v153, 81920, v141
v_lshl_or_b32 v208, v205, 1, v204
v_and_b32 v209, 2, v0
v_lshl_or_b32 v209, v206, 2, v209
v_and_or_b32 v209, v202, 1, v209
v_xor_b32 v209, v209, v208
v_lshlrev_b32 v209, 4, v209
v_lshl_add_u32 v20, v201, 7, v209
v_xor_b32 v21, 64, v20
v_lshrrev_b32 v208, 2, v0
v_lshlrev_b32 v208, 7, v208
v_lshl_add_u32 v208, v203, 3, v208
v_lshl_add_u32 v8, v207, 5, v208
v_xor_b32 v9, 32, v8
v_xor_b32 v10, 64, v8
v_xor_b32 v11, 96, v8
s_lshl_b32 s64, s51, 6
v_xor_b32 v208, s64, v8
v_add_u32 v26, s63, v208
v_xor_b32 v27, 32, v26
v_xor_b32 v28, 0x4000, v26
v_xor_b32 v29, 0x4000, v27
v_add_u32 v12, 65536, v8
v_add_u32 v30, 65536, v26
v_add_u32 v13, 65536, v9
v_add_u32 v31, 65536, v27
v_add_u32 v14, 65536, v10
v_add_u32 v32, 65536, v28
v_add_u32 v15, 65536, v11
v_add_u32 v33, 65536, v29
v_add_u32 v22, 65536, v20
v_add_u32 v23, 65536, v21
v_add_u32 v16, 131072, v8
v_add_u32 v34, 131072, v26
v_add_u32 v17, 131072, v9
v_add_u32 v35, 131072, v27
v_add_u32 v18, 131072, v10
v_add_u32 v36, 131072, v28
v_add_u32 v19, 131072, v11
v_add_u32 v37, 131072, v29
v_add_u32 v24, 131072, v20
v_add_u32 v25, 131072, v21
s_mul_i32 s63, s20, 296960
v_lshrrev_b32 v208, 3, v201
v_mul_u32_u24 v208, 74112, v208
v_lshl_add_u32 v208, v201, 4, v208
v_lshl_add_u32 v208, v200, 7, v208
v_add_u32 v2, s63, v208
s_add_u32 s63, s20, 12
s_lshl_b32 s63, s63, 13
v_lshl_add_u32 v3, v0, 4, s63
v_xor_b32 v4, 0x2000, v3
v_add_u32 v5, 12, v203
v_lshlrev_b32 v5, 13, v5
s_lshl_b32 s63, s20, 2
s_sub_u32 s63, s52, s63
v_bfe_u32 v208, v0, 3, 1
v_cmp_eq_u32 s[94:95], s63, v208
s_sub_u32 s63, s63, 2
v_cmp_eq_u32 s[96:97], s63, v208
	s_barrier
	ds_read_b128 v[184:187], v154 offset:0
	v_mov_b32 v168, v38
	v_mov_b32 v169, v38
	ds_read_b64_tr_b16 v[200:201], v156 offset:8192
	v_mov_b32 v170, v38
	v_mov_b32 v171, v38
	ds_read_b64_tr_b16 v[202:203], v156 offset:8704
	v_mov_b32 v172, v1
	ds_read_b128 v[188:191], v155 offset:0
	v_mov_b32 v173, v1
	v_mov_b32 v174, v1
	v_mov_b32 v175, v1
	v_mov_b32 v255, 0x3f803f80
	ds_read_b64_tr_b16 v[204:205], v156 offset:12288
	v_mov_b32 v254, 0x3f803f80
	v_mov_b32 v253, 0x3f803f80
	ds_read_b64_tr_b16 v[206:207], v156 offset:12800
	v_mov_b32 v252, 0x3f803f80
	ds_read_b128 v[192:195], v154 offset:2048
	s_mov_b32 s22, s65
	ds_read_b128 v[196:199], v155 offset:2048
	ds_read_b64_tr_b16 v[208:209], v157 offset:8192
	ds_read_b64_tr_b16 v[210:211], v157 offset:8704
	ds_read_b64_tr_b16 v[212:213], v157 offset:12288
	ds_read_b64_tr_b16 v[214:215], v157 offset:12800
	s_waitcnt lgkmcnt(9)
	v_mfma_f32_16x16x32_bf16 v[40:43], v[200:203], v[184:187], 0
	s_waitcnt lgkmcnt(6)
	ds_read_b64_tr_b16 v[216:217], v158 offset:8192
	ds_read_b64_tr_b16 v[218:219], v158 offset:8704
	ds_read_b64_tr_b16 v[220:221], v158 offset:12288
	ds_read_b64_tr_b16 v[222:223], v158 offset:12800
	v_mfma_f32_16x16x32_bf16 v[40:43], v[204:207], v[188:191], v[40:43]
	s_waitcnt lgkmcnt(9)
	v_mfma_f32_16x16x32_bf16 v[44:47], v[200:203], v[192:195], 0
	s_waitcnt lgkmcnt(8)
	v_mfma_f32_16x16x32_bf16 v[44:47], v[204:207], v[196:199], v[44:47]
	s_waitcnt lgkmcnt(6)
	ds_read_b64_tr_b16 v[224:225], v159 offset:8192
	ds_read_b64_tr_b16 v[226:227], v159 offset:8704
	v_mfma_f32_16x16x32_bf16 v[48:51], v[208:211], v[184:187], 0
	s_waitcnt lgkmcnt(6)
	ds_read_b64_tr_b16 v[228:229], v159 offset:12288
	ds_read_b64_tr_b16 v[230:231], v159 offset:12800
	v_mfma_f32_16x16x32_bf16 v[48:51], v[212:215], v[188:191], v[48:51]
	v_mfma_f32_16x16x32_bf16 v[52:55], v[208:211], v[192:195], 0
	ds_read_b64_tr_b16 v[232:233], v156 offset:16384
	ds_read_b64_tr_b16 v[234:235], v156 offset:16896
	v_mfma_f32_16x16x32_bf16 v[52:55], v[212:215], v[196:199], v[52:55]
	s_waitcnt lgkmcnt(8)
	ds_read_b64_tr_b16 v[236:237], v156 offset:20480
	v_mfma_f32_16x16x32_bf16 v[56:59], v[216:219], v[184:187], 0
	s_waitcnt lgkmcnt(7)
	ds_read_b64_tr_b16 v[238:239], v156 offset:20992
	v_mfma_f32_16x16x32_bf16 v[56:59], v[220:223], v[188:191], v[56:59]
	v_mfma_f32_16x16x32_bf16 v[60:63], v[216:219], v[192:195], 0
	v_mfma_f32_16x16x32_bf16 v[60:63], v[220:223], v[196:199], v[60:63]
	s_waitcnt lgkmcnt(6)
	ds_read_b64_tr_b16 v[240:241], v157 offset:16384
	ds_read_b64_tr_b16 v[242:243], v157 offset:16896
	v_mfma_f32_16x16x32_bf16 v[64:67], v[224:227], v[184:187], 0
	s_waitcnt lgkmcnt(6)
	ds_read_b64_tr_b16 v[244:245], v157 offset:20480
	ds_read_b64_tr_b16 v[246:247], v157 offset:20992
	v_mfma_f32_16x16x32_bf16 v[64:67], v[228:231], v[188:191], v[64:67]
	v_mfma_f32_16x16x32_bf16 v[68:71], v[224:227], v[192:195], 0
	v_mfma_f32_16x16x32_bf16 v[68:71], v[228:231], v[196:199], v[68:71]
	s_waitcnt lgkmcnt(6)
	v_mfma_f32_16x16x32_bf16 v[72:75], v[232:235], v[184:187], 0
	s_waitcnt lgkmcnt(4)
	ds_read_b64_tr_b16 v[248:249], v158 offset:16384
	ds_read_b64_tr_b16 v[250:251], v158 offset:16896
	v_mfma_f32_16x16x32_bf16 v[72:75], v[236:239], v[188:191], v[72:75]
	ds_read_b64_tr_b16 v[200:201], v158 offset:20480
	v_mfma_f32_16x16x32_bf16 v[76:79], v[232:235], v[192:195], 0
	ds_read_b64_tr_b16 v[202:203], v158 offset:20992
	v_mfma_f32_16x16x32_bf16 v[76:79], v[236:239], v[196:199], v[76:79]
	s_waitcnt lgkmcnt(6)
	v_mfma_f32_16x16x32_bf16 v[80:83], v[240:243], v[184:187], 0
	s_waitcnt lgkmcnt(4)
	ds_read_b64_tr_b16 v[204:205], v159 offset:16384
	ds_read_b64_tr_b16 v[206:207], v159 offset:16896
	v_mfma_f32_16x16x32_bf16 v[80:83], v[244:247], v[188:191], v[80:83]
	s_barrier
	ds_read_b64_tr_b16 v[208:209], v159 offset:20480
	ds_read_b64_tr_b16 v[210:211], v159 offset:20992
	v_mfma_f32_16x16x32_bf16 v[84:87], v[240:243], v[192:195], 0
	v_mfma_f32_16x16x32_bf16 v[84:87], v[244:247], v[196:199], v[84:87]
	s_waitcnt lgkmcnt(6)
	ds_read_b128 v[104:107], v136 offset:0
	v_mfma_f32_16x16x32_bf16 v[88:91], v[248:251], v[184:187], 0
	s_waitcnt lgkmcnt(5)
	ds_read_b64_tr_b16 v[212:213], v138 offset:8192
	ds_read_b64_tr_b16 v[214:215], v138 offset:8704
	v_mfma_f32_16x16x32_bf16 v[88:91], v[200:203], v[188:191], v[88:91]
	v_mfma_f32_16x16x32_bf16 v[92:95], v[248:251], v[192:195], 0
	ds_read_b128 v[108:111], v137 offset:0
	v_mfma_f32_16x16x32_bf16 v[92:95], v[200:203], v[196:199], v[92:95]
	s_waitcnt lgkmcnt(6)
	ds_read_b64_tr_b16 v[216:217], v138 offset:12288
	ds_read_b64_tr_b16 v[218:219], v138 offset:12800
	v_mfma_f32_16x16x32_bf16 v[96:99], v[204:207], v[184:187], 0
	s_waitcnt lgkmcnt(6)
	ds_read_b128 v[112:115], v136 offset:2048
	v_mfma_f32_16x16x32_bf16 v[96:99], v[208:211], v[188:191], v[96:99]
	ds_read_b128 v[116:119], v137 offset:2048
	v_mfma_f32_16x16x32_bf16 v[100:103], v[204:207], v[192:195], 0
	ds_read_b64_tr_b16 v[220:221], v139 offset:8192
	v_mfma_f32_16x16x32_bf16 v[100:103], v[208:211], v[196:199], v[100:103]
	s_waitcnt lgkmcnt(6)
	ds_read_b64_tr_b16 v[222:223], v139 offset:8704
	ds_read_b64_tr_b16 v[224:225], v139 offset:12288
	v_mfma_f32_16x16x32_bf16 v[40:43], v[212:215], v[104:107], v[40:43]
	s_waitcnt lgkmcnt(5)
	ds_read_b64_tr_b16 v[226:227], v139 offset:12800
	ds_read_b64_tr_b16 v[228:229], v140 offset:8192
	ds_read_b64_tr_b16 v[230:231], v140 offset:8704
	ds_read_b64_tr_b16 v[232:233], v140 offset:12288
	ds_read_b64_tr_b16 v[234:235], v140 offset:12800
	v_mfma_f32_16x16x32_bf16 v[40:43], v[216:219], v[108:111], v[40:43]
	s_waitcnt lgkmcnt(9)
	v_mfma_f32_16x16x32_bf16 v[44:47], v[212:215], v[112:115], v[44:47]
	s_waitcnt lgkmcnt(8)
	v_mfma_f32_16x16x32_bf16 v[44:47], v[216:219], v[116:119], v[44:47]
	s_waitcnt lgkmcnt(6)
	ds_read_b64_tr_b16 v[236:237], v141 offset:8192
	ds_read_b64_tr_b16 v[238:239], v141 offset:8704
	v_mfma_f32_16x16x32_bf16 v[48:51], v[220:223], v[104:107], v[48:51]
	s_waitcnt lgkmcnt(6)
	ds_read_b64_tr_b16 v[240:241], v141 offset:12288
	ds_read_b64_tr_b16 v[242:243], v141 offset:12800
	v_mfma_f32_16x16x32_bf16 v[48:51], v[224:227], v[108:111], v[48:51]
	v_mfma_f32_16x16x32_bf16 v[52:55], v[220:223], v[112:115], v[52:55]
	ds_read_b64_tr_b16 v[244:245], v138 offset:16384
	ds_read_b64_tr_b16 v[246:247], v138 offset:16896
	v_mfma_f32_16x16x32_bf16 v[52:55], v[224:227], v[116:119], v[52:55]
	s_waitcnt lgkmcnt(8)
	ds_read_b64_tr_b16 v[248:249], v138 offset:20480
	v_mfma_f32_16x16x32_bf16 v[56:59], v[228:231], v[104:107], v[56:59]
	s_waitcnt lgkmcnt(7)
	ds_read_b64_tr_b16 v[250:251], v138 offset:20992
	v_mfma_f32_16x16x32_bf16 v[56:59], v[232:235], v[108:111], v[56:59]
	v_mfma_f32_16x16x32_bf16 v[60:63], v[228:231], v[112:115], v[60:63]
	v_mfma_f32_16x16x32_bf16 v[60:63], v[232:235], v[116:119], v[60:63]
	s_waitcnt lgkmcnt(6)
	ds_read_b64_tr_b16 v[200:201], v139 offset:16384
	ds_read_b64_tr_b16 v[202:203], v139 offset:16896
	v_mfma_f32_16x16x32_bf16 v[64:67], v[236:239], v[104:107], v[64:67]
	s_waitcnt lgkmcnt(6)
	ds_read_b64_tr_b16 v[204:205], v139 offset:20480
	ds_read_b64_tr_b16 v[206:207], v139 offset:20992
	v_mfma_f32_16x16x32_bf16 v[64:67], v[240:243], v[108:111], v[64:67]
	v_mfma_f32_16x16x32_bf16 v[68:71], v[236:239], v[112:115], v[68:71]
	v_mfma_f32_16x16x32_bf16 v[68:71], v[240:243], v[116:119], v[68:71]
	s_waitcnt lgkmcnt(6)
	v_mfma_f32_16x16x32_bf16 v[72:75], v[244:247], v[104:107], v[72:75]
	s_waitcnt lgkmcnt(4)
	ds_read_b64_tr_b16 v[208:209], v140 offset:16384
	ds_read_b64_tr_b16 v[210:211], v140 offset:16896
	v_mfma_f32_16x16x32_bf16 v[72:75], v[248:251], v[108:111], v[72:75]
	ds_read_b64_tr_b16 v[212:213], v140 offset:20480
	v_mfma_f32_16x16x32_bf16 v[76:79], v[244:247], v[112:115], v[76:79]
	ds_read_b64_tr_b16 v[214:215], v140 offset:20992
	v_mfma_f32_16x16x32_bf16 v[76:79], v[248:251], v[116:119], v[76:79]
	s_waitcnt lgkmcnt(6)
	v_mfma_f32_16x16x32_bf16 v[80:83], v[200:203], v[104:107], v[80:83]
	s_waitcnt lgkmcnt(4)
	ds_read_b64_tr_b16 v[216:217], v141 offset:16384
	ds_read_b64_tr_b16 v[218:219], v141 offset:16896
	v_mfma_f32_16x16x32_bf16 v[80:83], v[204:207], v[108:111], v[80:83]
	s_barrier
	ds_read_b64_tr_b16 v[220:221], v141 offset:20480
	ds_read_b64_tr_b16 v[222:223], v141 offset:20992
	v_mfma_f32_16x16x32_bf16 v[84:87], v[200:203], v[112:115], v[84:87]
	v_mfma_f32_16x16x32_bf16 v[84:87], v[204:207], v[116:119], v[84:87]
	s_waitcnt lgkmcnt(6)
	ds_read_b128 v[184:187], v142 offset:0
	v_mfma_f32_16x16x32_bf16 v[88:91], v[208:211], v[104:107], v[88:91]
	s_waitcnt lgkmcnt(5)
	ds_read_b64_tr_b16 v[224:225], v144 offset:8192
	ds_read_b64_tr_b16 v[226:227], v144 offset:8704
	v_mfma_f32_16x16x32_bf16 v[88:91], v[212:215], v[108:111], v[88:91]
	v_mfma_f32_16x16x32_bf16 v[92:95], v[208:211], v[112:115], v[92:95]
	ds_read_b128 v[188:191], v143 offset:0
	v_mfma_f32_16x16x32_bf16 v[92:95], v[212:215], v[116:119], v[92:95]
	s_waitcnt lgkmcnt(6)
	ds_read_b64_tr_b16 v[228:229], v144 offset:12288
	ds_read_b64_tr_b16 v[230:231], v144 offset:12800
	v_mfma_f32_16x16x32_bf16 v[96:99], v[216:219], v[104:107], v[96:99]
	s_waitcnt lgkmcnt(6)
	ds_read_b128 v[192:195], v142 offset:2048
	v_mfma_f32_16x16x32_bf16 v[96:99], v[220:223], v[108:111], v[96:99]
	ds_read_b128 v[196:199], v143 offset:2048
	v_mfma_f32_16x16x32_bf16 v[100:103], v[216:219], v[112:115], v[100:103]
	ds_read_b64_tr_b16 v[232:233], v145 offset:8192
	v_mfma_f32_16x16x32_bf16 v[100:103], v[220:223], v[116:119], v[100:103]
	s_waitcnt lgkmcnt(6)
	ds_read_b64_tr_b16 v[234:235], v145 offset:8704
	ds_read_b64_tr_b16 v[236:237], v145 offset:12288
	v_mfma_f32_16x16x32_bf16 v[40:43], v[224:227], v[184:187], v[40:43]
	s_waitcnt lgkmcnt(5)
	ds_read_b64_tr_b16 v[238:239], v145 offset:12800
	ds_read_b64_tr_b16 v[240:241], v146 offset:8192
	ds_read_b64_tr_b16 v[242:243], v146 offset:8704
	ds_read_b64_tr_b16 v[244:245], v146 offset:12288
	ds_read_b64_tr_b16 v[246:247], v146 offset:12800
	v_mfma_f32_16x16x32_bf16 v[40:43], v[228:231], v[188:191], v[40:43]
	s_waitcnt lgkmcnt(9)
	v_mfma_f32_16x16x32_bf16 v[44:47], v[224:227], v[192:195], v[44:47]
	s_waitcnt lgkmcnt(8)
	v_mfma_f32_16x16x32_bf16 v[44:47], v[228:231], v[196:199], v[44:47]
	s_waitcnt lgkmcnt(6)
	ds_read_b64_tr_b16 v[248:249], v147 offset:8192
	ds_read_b64_tr_b16 v[250:251], v147 offset:8704
	v_mfma_f32_16x16x32_bf16 v[48:51], v[232:235], v[184:187], v[48:51]
	s_waitcnt lgkmcnt(6)
	ds_read_b64_tr_b16 v[200:201], v147 offset:12288
	ds_read_b64_tr_b16 v[202:203], v147 offset:12800
	v_mfma_f32_16x16x32_bf16 v[48:51], v[236:239], v[188:191], v[48:51]
	v_mfma_f32_16x16x32_bf16 v[52:55], v[232:235], v[192:195], v[52:55]
	ds_read_b64_tr_b16 v[204:205], v144 offset:16384
	ds_read_b64_tr_b16 v[206:207], v144 offset:16896
	v_mfma_f32_16x16x32_bf16 v[52:55], v[236:239], v[196:199], v[52:55]
	s_waitcnt lgkmcnt(8)
	ds_read_b64_tr_b16 v[208:209], v144 offset:20480
	v_mfma_f32_16x16x32_bf16 v[56:59], v[240:243], v[184:187], v[56:59]
	s_waitcnt lgkmcnt(7)
	ds_read_b64_tr_b16 v[210:211], v144 offset:20992
	v_mfma_f32_16x16x32_bf16 v[56:59], v[244:247], v[188:191], v[56:59]
	v_mfma_f32_16x16x32_bf16 v[60:63], v[240:243], v[192:195], v[60:63]
	v_mfma_f32_16x16x32_bf16 v[60:63], v[244:247], v[196:199], v[60:63]
	s_waitcnt lgkmcnt(6)
	ds_read_b64_tr_b16 v[212:213], v145 offset:16384
	ds_read_b64_tr_b16 v[214:215], v145 offset:16896
	v_mfma_f32_16x16x32_bf16 v[64:67], v[248:251], v[184:187], v[64:67]
	s_waitcnt lgkmcnt(6)
	ds_read_b64_tr_b16 v[216:217], v145 offset:20480
	ds_read_b64_tr_b16 v[218:219], v145 offset:20992
	v_mfma_f32_16x16x32_bf16 v[64:67], v[200:203], v[188:191], v[64:67]
	v_mfma_f32_16x16x32_bf16 v[68:71], v[248:251], v[192:195], v[68:71]
	v_mfma_f32_16x16x32_bf16 v[68:71], v[200:203], v[196:199], v[68:71]
	s_waitcnt lgkmcnt(6)
	v_mfma_f32_16x16x32_bf16 v[72:75], v[204:207], v[184:187], v[72:75]
	s_waitcnt lgkmcnt(4)
	ds_read_b64_tr_b16 v[220:221], v146 offset:16384
	ds_read_b64_tr_b16 v[222:223], v146 offset:16896
	v_mfma_f32_16x16x32_bf16 v[72:75], v[208:211], v[188:191], v[72:75]
	ds_read_b64_tr_b16 v[224:225], v146 offset:20480
	v_mfma_f32_16x16x32_bf16 v[76:79], v[204:207], v[192:195], v[76:79]
	ds_read_b64_tr_b16 v[226:227], v146 offset:20992
	v_mfma_f32_16x16x32_bf16 v[76:79], v[208:211], v[196:199], v[76:79]
	s_waitcnt lgkmcnt(6)
	v_mfma_f32_16x16x32_bf16 v[80:83], v[212:215], v[184:187], v[80:83]
	s_waitcnt lgkmcnt(4)
	ds_read_b64_tr_b16 v[228:229], v147 offset:16384
	ds_read_b64_tr_b16 v[230:231], v147 offset:16896
	v_mfma_f32_16x16x32_bf16 v[80:83], v[216:219], v[188:191], v[80:83]
	s_barrier
	ds_read_b64_tr_b16 v[232:233], v147 offset:20480
	ds_read_b64_tr_b16 v[234:235], v147 offset:20992
	v_mfma_f32_16x16x32_bf16 v[84:87], v[212:215], v[192:195], v[84:87]
	v_mfma_f32_16x16x32_bf16 v[84:87], v[216:219], v[196:199], v[84:87]
	s_waitcnt lgkmcnt(6)
	v_mfma_f32_16x16x32_bf16 v[88:91], v[220:223], v[184:187], v[88:91]
	s_waitcnt lgkmcnt(4)
	ds_read_b128 v[104:107], v148 offset:0
	v_mfma_f32_16x16x32_bf16 v[88:91], v[224:227], v[188:191], v[88:91]
	ds_read_b64_tr_b16 v[236:237], v150 offset:8192
	ds_read_b64_tr_b16 v[238:239], v150 offset:8704
	v_mfma_f32_16x16x32_bf16 v[92:95], v[220:223], v[192:195], v[92:95]
	v_mfma_f32_16x16x32_bf16 v[92:95], v[224:227], v[196:199], v[92:95]
	s_waitcnt lgkmcnt(5)
	ds_read_b128 v[108:111], v149 offset:0
	v_mfma_f32_16x16x32_bf16 v[96:99], v[228:231], v[184:187], v[96:99]
	s_waitcnt lgkmcnt(4)
	ds_read_b64_tr_b16 v[240:241], v150 offset:12288
	ds_read_b64_tr_b16 v[242:243], v150 offset:12800
	ds_read_b128 v[112:115], v148 offset:2048
	v_mfma_f32_16x16x32_bf16 v[96:99], v[232:235], v[188:191], v[96:99]
	ds_read_b128 v[116:119], v149 offset:2048
	v_mfma_f32_16x16x32_bf16 v[100:103], v[228:231], v[192:195], v[100:103]
	v_mfma_f32_16x16x32_bf16 v[100:103], v[232:235], v[196:199], v[100:103]
	s_waitcnt lgkmcnt(5)
	buffer_store_dwordx4 v[164:167], v160, s[32:35], 0 offen sc1
	ds_read_b64_tr_b16 v[244:245], v151 offset:8192
	ds_read_b64_tr_b16 v[246:247], v151 offset:8704
	ds_read_b64_tr_b16 v[248:249], v151 offset:12288
	v_mfma_f32_16x16x32_bf16 v[40:43], v[236:239], v[104:107], v[40:43]
	s_waitcnt lgkmcnt(5)
	ds_read_b64_tr_b16 v[250:251], v151 offset:12800
	ds_read_b64_tr_b16 v[200:201], v152 offset:8192
	ds_read_b64_tr_b16 v[202:203], v152 offset:8704
	ds_read_b64_tr_b16 v[204:205], v152 offset:12288
	v_mfma_f32_16x16x32_bf16 v[40:43], v[240:243], v[108:111], v[40:43]
	s_waitcnt lgkmcnt(8)
	ds_read_b64_tr_b16 v[206:207], v152 offset:12800
	v_mfma_f32_16x16x32_bf16 v[44:47], v[236:239], v[112:115], v[44:47]
	s_waitcnt lgkmcnt(8)
	v_mfma_f32_16x16x32_bf16 v[44:47], v[240:243], v[116:119], v[44:47]
	s_waitcnt lgkmcnt(6)
	ds_read_b64_tr_b16 v[208:209], v153 offset:8192
	ds_read_b64_tr_b16 v[210:211], v153 offset:8704
	ds_read_b64_tr_b16 v[212:213], v153 offset:12288
	ds_read_b64_tr_b16 v[214:215], v153 offset:12800
	v_mfma_f32_16x16x32_bf16 v[48:51], v[244:247], v[104:107], v[48:51]
	s_waitcnt lgkmcnt(8)
	v_mfma_f32_16x16x32_bf16 v[48:51], v[248:251], v[108:111], v[48:51]
	v_mfma_f32_16x16x32_bf16 v[52:55], v[244:247], v[112:115], v[52:55]
	ds_read_b64_tr_b16 v[216:217], v150 offset:16384
	ds_read_b64_tr_b16 v[218:219], v150 offset:16896
	v_mfma_f32_16x16x32_bf16 v[52:55], v[248:251], v[116:119], v[52:55]
	s_waitcnt lgkmcnt(8)
	ds_read_b64_tr_b16 v[220:221], v150 offset:20480
	v_mfma_f32_16x16x32_bf16 v[56:59], v[200:203], v[104:107], v[56:59]
	s_waitcnt lgkmcnt(7)
	ds_read_b64_tr_b16 v[222:223], v150 offset:20992
	v_mfma_f32_16x16x32_bf16 v[56:59], v[204:207], v[108:111], v[56:59]
	v_mfma_f32_16x16x32_bf16 v[60:63], v[200:203], v[112:115], v[60:63]
	v_mfma_f32_16x16x32_bf16 v[60:63], v[204:207], v[116:119], v[60:63]
	s_waitcnt lgkmcnt(6)
	ds_read_b64_tr_b16 v[224:225], v151 offset:16384
	ds_read_b64_tr_b16 v[226:227], v151 offset:16896
	v_mfma_f32_16x16x32_bf16 v[64:67], v[208:211], v[104:107], v[64:67]
	s_waitcnt lgkmcnt(6)
	ds_read_b64_tr_b16 v[228:229], v151 offset:20480
	ds_read_b64_tr_b16 v[230:231], v151 offset:20992
	v_mfma_f32_16x16x32_bf16 v[64:67], v[212:215], v[108:111], v[64:67]
	v_mfma_f32_16x16x32_bf16 v[68:71], v[208:211], v[112:115], v[68:71]
	v_mfma_f32_16x16x32_bf16 v[68:71], v[212:215], v[116:119], v[68:71]
	s_waitcnt lgkmcnt(6)
	v_mfma_f32_16x16x32_bf16 v[72:75], v[216:219], v[104:107], v[72:75]
	s_waitcnt lgkmcnt(4)
	ds_read_b64_tr_b16 v[232:233], v152 offset:16384
	ds_read_b64_tr_b16 v[234:235], v152 offset:16896
	v_mfma_f32_16x16x32_bf16 v[72:75], v[220:223], v[108:111], v[72:75]
	ds_read_b64_tr_b16 v[236:237], v152 offset:20480
	v_mfma_f32_16x16x32_bf16 v[76:79], v[216:219], v[112:115], v[76:79]
	ds_read_b64_tr_b16 v[238:239], v152 offset:20992
	v_mfma_f32_16x16x32_bf16 v[76:79], v[220:223], v[116:119], v[76:79]
	s_waitcnt lgkmcnt(6)
	v_mfma_f32_16x16x32_bf16 v[80:83], v[224:227], v[104:107], v[80:83]
	s_waitcnt lgkmcnt(4)
	ds_read_b64_tr_b16 v[240:241], v153 offset:16384
	ds_read_b64_tr_b16 v[242:243], v153 offset:16896
	v_mfma_f32_16x16x32_bf16 v[80:83], v[228:231], v[108:111], v[80:83]
	s_barrier
	ds_read_b64_tr_b16 v[244:245], v153 offset:20480
	ds_read_b64_tr_b16 v[246:247], v153 offset:20992
	v_mfma_f32_16x16x32_bf16 v[84:87], v[224:227], v[112:115], v[84:87]
	v_mfma_f32_16x16x32_bf16 v[84:87], v[228:231], v[116:119], v[84:87]
	s_waitcnt lgkmcnt(6)
	ds_read_b128 v[184:187], v154 offset:0
	v_mfma_f32_16x16x32_bf16 v[88:91], v[232:235], v[104:107], v[88:91]
	s_waitcnt lgkmcnt(5)
	ds_read_b64_tr_b16 v[248:249], v156 offset:8192
	ds_read_b64_tr_b16 v[250:251], v156 offset:8704
	v_mfma_f32_16x16x32_bf16 v[88:91], v[236:239], v[108:111], v[88:91]
	v_mfma_f32_16x16x32_bf16 v[92:95], v[232:235], v[112:115], v[92:95]
	ds_read_b128 v[188:191], v155 offset:0
	v_mfma_f32_16x16x32_bf16 v[92:95], v[236:239], v[116:119], v[92:95]
	s_waitcnt lgkmcnt(6)
	ds_read_b64_tr_b16 v[200:201], v156 offset:12288
	ds_read_b64_tr_b16 v[202:203], v156 offset:12800
	v_mfma_f32_16x16x32_bf16 v[96:99], v[240:243], v[104:107], v[96:99]
	s_waitcnt lgkmcnt(6)
	ds_read_b128 v[192:195], v154 offset:2048
	v_mfma_f32_16x16x32_bf16 v[96:99], v[244:247], v[108:111], v[96:99]
	ds_read_b128 v[196:199], v155 offset:2048
	v_mfma_f32_16x16x32_bf16 v[100:103], v[240:243], v[112:115], v[100:103]
	ds_read_b64_tr_b16 v[204:205], v157 offset:8192
	v_mfma_f32_16x16x32_bf16 v[100:103], v[244:247], v[116:119], v[100:103]
	s_waitcnt lgkmcnt(6)
	ds_read_b64_tr_b16 v[206:207], v157 offset:8704
	ds_read_b64_tr_b16 v[208:209], v157 offset:12288
	v_mfma_f32_16x16x32_bf16 v[40:43], v[248:251], v[184:187], v[40:43]
	s_waitcnt lgkmcnt(5)
	ds_read_b64_tr_b16 v[210:211], v157 offset:12800
	ds_read_b64_tr_b16 v[212:213], v158 offset:8192
	ds_read_b64_tr_b16 v[214:215], v158 offset:8704
	ds_read_b64_tr_b16 v[216:217], v158 offset:12288
	ds_read_b64_tr_b16 v[218:219], v158 offset:12800
	v_mfma_f32_16x16x32_bf16 v[40:43], v[200:203], v[188:191], v[40:43]
	s_waitcnt lgkmcnt(9)
	v_mfma_f32_16x16x32_bf16 v[44:47], v[248:251], v[192:195], v[44:47]
	s_waitcnt lgkmcnt(8)
	v_mfma_f32_16x16x32_bf16 v[44:47], v[200:203], v[196:199], v[44:47]
	s_waitcnt lgkmcnt(6)
	ds_read_b64_tr_b16 v[220:221], v159 offset:8192
	ds_read_b64_tr_b16 v[222:223], v159 offset:8704
	v_mfma_f32_16x16x32_bf16 v[48:51], v[204:207], v[184:187], v[48:51]
	s_waitcnt lgkmcnt(6)
	ds_read_b64_tr_b16 v[224:225], v159 offset:12288
	ds_read_b64_tr_b16 v[226:227], v159 offset:12800
	v_mfma_f32_16x16x32_bf16 v[48:51], v[208:211], v[188:191], v[48:51]
	v_mfma_f32_16x16x32_bf16 v[52:55], v[204:207], v[192:195], v[52:55]
	ds_read_b64_tr_b16 v[228:229], v156 offset:16384
	ds_read_b64_tr_b16 v[230:231], v156 offset:16896
	v_mfma_f32_16x16x32_bf16 v[52:55], v[208:211], v[196:199], v[52:55]
	s_waitcnt lgkmcnt(8)
	ds_read_b64_tr_b16 v[232:233], v156 offset:20480
	v_mfma_f32_16x16x32_bf16 v[56:59], v[212:215], v[184:187], v[56:59]
	s_waitcnt lgkmcnt(7)
	ds_read_b64_tr_b16 v[234:235], v156 offset:20992
	v_mfma_f32_16x16x32_bf16 v[56:59], v[216:219], v[188:191], v[56:59]
	v_mfma_f32_16x16x32_bf16 v[60:63], v[212:215], v[192:195], v[60:63]
	v_mfma_f32_16x16x32_bf16 v[60:63], v[216:219], v[196:199], v[60:63]
	s_waitcnt lgkmcnt(6)
	ds_read_b64_tr_b16 v[236:237], v157 offset:16384
	ds_read_b64_tr_b16 v[238:239], v157 offset:16896
	v_mfma_f32_16x16x32_bf16 v[64:67], v[220:223], v[184:187], v[64:67]
	s_waitcnt lgkmcnt(6)
	ds_read_b64_tr_b16 v[240:241], v157 offset:20480
	ds_read_b64_tr_b16 v[242:243], v157 offset:20992
	v_mfma_f32_16x16x32_bf16 v[64:67], v[224:227], v[188:191], v[64:67]
	v_mfma_f32_16x16x32_bf16 v[68:71], v[220:223], v[192:195], v[68:71]
	v_mfma_f32_16x16x32_bf16 v[68:71], v[224:227], v[196:199], v[68:71]
	s_waitcnt lgkmcnt(6)
	v_mfma_f32_16x16x32_bf16 v[72:75], v[228:231], v[184:187], v[72:75]
	s_waitcnt lgkmcnt(4)
	ds_read_b64_tr_b16 v[244:245], v158 offset:16384
	ds_read_b64_tr_b16 v[246:247], v158 offset:16896
	v_mfma_f32_16x16x32_bf16 v[72:75], v[232:235], v[188:191], v[72:75]
	ds_read_b64_tr_b16 v[248:249], v158 offset:20480
	v_mfma_f32_16x16x32_bf16 v[76:79], v[228:231], v[192:195], v[76:79]
	ds_read_b64_tr_b16 v[250:251], v158 offset:20992
	v_mfma_f32_16x16x32_bf16 v[76:79], v[232:235], v[196:199], v[76:79]
	s_waitcnt lgkmcnt(6)
	v_mfma_f32_16x16x32_bf16 v[80:83], v[236:239], v[184:187], v[80:83]
	s_waitcnt lgkmcnt(4)
	ds_read_b64_tr_b16 v[200:201], v159 offset:16384
	ds_read_b64_tr_b16 v[202:203], v159 offset:16896
	v_mfma_f32_16x16x32_bf16 v[80:83], v[240:243], v[188:191], v[80:83]
	s_barrier
	ds_read_b64_tr_b16 v[204:205], v159 offset:20480
	ds_read_b64_tr_b16 v[206:207], v159 offset:20992
	v_mfma_f32_16x16x32_bf16 v[84:87], v[236:239], v[192:195], v[84:87]
	v_mfma_f32_16x16x32_bf16 v[84:87], v[240:243], v[196:199], v[84:87]
	s_waitcnt lgkmcnt(6)
	ds_read_b128 v[104:107], v136 offset:0
	v_mfma_f32_16x16x32_bf16 v[88:91], v[244:247], v[184:187], v[88:91]
	s_waitcnt lgkmcnt(5)
	ds_read_b64_tr_b16 v[208:209], v138 offset:8192
	ds_read_b64_tr_b16 v[210:211], v138 offset:8704
	v_mfma_f32_16x16x32_bf16 v[88:91], v[248:251], v[188:191], v[88:91]
	v_mfma_f32_16x16x32_bf16 v[92:95], v[244:247], v[192:195], v[92:95]
	ds_read_b128 v[108:111], v137 offset:0
	v_mfma_f32_16x16x32_bf16 v[92:95], v[248:251], v[196:199], v[92:95]
	s_waitcnt lgkmcnt(6)
	ds_read_b64_tr_b16 v[212:213], v138 offset:12288
	ds_read_b64_tr_b16 v[214:215], v138 offset:12800
	v_mfma_f32_16x16x32_bf16 v[96:99], v[200:203], v[184:187], v[96:99]
	s_waitcnt lgkmcnt(6)
	ds_read_b128 v[112:115], v136 offset:2048
	v_mfma_f32_16x16x32_bf16 v[96:99], v[204:207], v[188:191], v[96:99]
	ds_read_b128 v[116:119], v137 offset:2048
	v_mfma_f32_16x16x32_bf16 v[100:103], v[200:203], v[192:195], v[100:103]
	ds_read_b64_tr_b16 v[216:217], v139 offset:8192
	v_mfma_f32_16x16x32_bf16 v[100:103], v[204:207], v[196:199], v[100:103]
	s_waitcnt lgkmcnt(6)
	ds_read_b64_tr_b16 v[218:219], v139 offset:8704
	ds_read_b64_tr_b16 v[220:221], v139 offset:12288
	v_mfma_f32_16x16x32_bf16 v[40:43], v[208:211], v[104:107], v[40:43]
	s_waitcnt lgkmcnt(5)
	ds_read_b64_tr_b16 v[222:223], v139 offset:12800
	ds_read_b64_tr_b16 v[224:225], v140 offset:8192
	ds_read_b64_tr_b16 v[226:227], v140 offset:8704
	ds_read_b64_tr_b16 v[228:229], v140 offset:12288
	ds_read_b64_tr_b16 v[230:231], v140 offset:12800
	v_mfma_f32_16x16x32_bf16 v[40:43], v[212:215], v[108:111], v[40:43]
	s_waitcnt lgkmcnt(9)
	v_mfma_f32_16x16x32_bf16 v[44:47], v[208:211], v[112:115], v[44:47]
	s_waitcnt lgkmcnt(8)
	v_mfma_f32_16x16x32_bf16 v[44:47], v[212:215], v[116:119], v[44:47]
	s_waitcnt lgkmcnt(6)
	ds_read_b64_tr_b16 v[232:233], v141 offset:8192
	ds_read_b64_tr_b16 v[234:235], v141 offset:8704
	v_mfma_f32_16x16x32_bf16 v[48:51], v[216:219], v[104:107], v[48:51]
	s_waitcnt lgkmcnt(6)
	ds_read_b64_tr_b16 v[236:237], v141 offset:12288
	ds_read_b64_tr_b16 v[238:239], v141 offset:12800
	v_mfma_f32_16x16x32_bf16 v[48:51], v[220:223], v[108:111], v[48:51]
	v_mfma_f32_16x16x32_bf16 v[52:55], v[216:219], v[112:115], v[52:55]
	ds_read_b64_tr_b16 v[240:241], v138 offset:16384
	ds_read_b64_tr_b16 v[242:243], v138 offset:16896
	v_mfma_f32_16x16x32_bf16 v[52:55], v[220:223], v[116:119], v[52:55]
	s_waitcnt lgkmcnt(8)
	ds_read_b64_tr_b16 v[244:245], v138 offset:20480
	v_mfma_f32_16x16x32_bf16 v[56:59], v[224:227], v[104:107], v[56:59]
	s_waitcnt lgkmcnt(7)
	ds_read_b64_tr_b16 v[246:247], v138 offset:20992
	v_mfma_f32_16x16x32_bf16 v[56:59], v[228:231], v[108:111], v[56:59]
	v_mfma_f32_16x16x32_bf16 v[60:63], v[224:227], v[112:115], v[60:63]
	v_mfma_f32_16x16x32_bf16 v[60:63], v[228:231], v[116:119], v[60:63]
	s_waitcnt lgkmcnt(6)
	ds_read_b64_tr_b16 v[248:249], v139 offset:16384
	ds_read_b64_tr_b16 v[250:251], v139 offset:16896
	v_mfma_f32_16x16x32_bf16 v[64:67], v[232:235], v[104:107], v[64:67]
	s_waitcnt lgkmcnt(6)
	ds_read_b64_tr_b16 v[200:201], v139 offset:20480
	ds_read_b64_tr_b16 v[202:203], v139 offset:20992
	v_mfma_f32_16x16x32_bf16 v[64:67], v[236:239], v[108:111], v[64:67]
	v_mfma_f32_16x16x32_bf16 v[68:71], v[232:235], v[112:115], v[68:71]
	v_mfma_f32_16x16x32_bf16 v[68:71], v[236:239], v[116:119], v[68:71]
	s_waitcnt lgkmcnt(6)
	v_mfma_f32_16x16x32_bf16 v[72:75], v[240:243], v[104:107], v[72:75]
	s_waitcnt lgkmcnt(4)
	ds_read_b64_tr_b16 v[204:205], v140 offset:16384
	ds_read_b64_tr_b16 v[206:207], v140 offset:16896
	v_mfma_f32_16x16x32_bf16 v[72:75], v[244:247], v[108:111], v[72:75]
	ds_read_b64_tr_b16 v[208:209], v140 offset:20480
	v_mfma_f32_16x16x32_bf16 v[76:79], v[240:243], v[112:115], v[76:79]
	ds_read_b64_tr_b16 v[210:211], v140 offset:20992
	v_mfma_f32_16x16x32_bf16 v[76:79], v[244:247], v[116:119], v[76:79]
	s_waitcnt lgkmcnt(6)
	v_mfma_f32_16x16x32_bf16 v[80:83], v[248:251], v[104:107], v[80:83]
	s_waitcnt lgkmcnt(4)
	ds_read_b64_tr_b16 v[212:213], v141 offset:16384
	ds_read_b64_tr_b16 v[214:215], v141 offset:16896
	v_mfma_f32_16x16x32_bf16 v[80:83], v[200:203], v[108:111], v[80:83]
	s_barrier
	ds_read_b64_tr_b16 v[216:217], v141 offset:20480
	ds_read_b64_tr_b16 v[218:219], v141 offset:20992
	v_mfma_f32_16x16x32_bf16 v[84:87], v[248:251], v[112:115], v[84:87]
	v_mfma_f32_16x16x32_bf16 v[84:87], v[200:203], v[116:119], v[84:87]
	s_waitcnt lgkmcnt(6)
	ds_read_b128 v[184:187], v142 offset:0
	v_mfma_f32_16x16x32_bf16 v[88:91], v[204:207], v[104:107], v[88:91]
	s_waitcnt lgkmcnt(5)
	ds_read_b64_tr_b16 v[220:221], v144 offset:8192
	ds_read_b64_tr_b16 v[222:223], v144 offset:8704
	v_mfma_f32_16x16x32_bf16 v[88:91], v[208:211], v[108:111], v[88:91]
	v_mfma_f32_16x16x32_bf16 v[92:95], v[204:207], v[112:115], v[92:95]
	ds_read_b128 v[188:191], v143 offset:0
	v_mfma_f32_16x16x32_bf16 v[92:95], v[208:211], v[116:119], v[92:95]
	s_waitcnt lgkmcnt(6)
	ds_read_b64_tr_b16 v[224:225], v144 offset:12288
	ds_read_b64_tr_b16 v[226:227], v144 offset:12800
	v_mfma_f32_16x16x32_bf16 v[96:99], v[212:215], v[104:107], v[96:99]
	s_waitcnt lgkmcnt(6)
	ds_read_b128 v[192:195], v142 offset:2048
	v_mfma_f32_16x16x32_bf16 v[96:99], v[216:219], v[108:111], v[96:99]
	ds_read_b128 v[196:199], v143 offset:2048
	v_mfma_f32_16x16x32_bf16 v[100:103], v[212:215], v[112:115], v[100:103]
	ds_read_b64_tr_b16 v[228:229], v145 offset:8192
	v_mfma_f32_16x16x32_bf16 v[100:103], v[216:219], v[116:119], v[100:103]
	s_waitcnt lgkmcnt(6)
	ds_read_b64_tr_b16 v[230:231], v145 offset:8704
	ds_read_b64_tr_b16 v[232:233], v145 offset:12288
	v_mfma_f32_16x16x32_bf16 v[40:43], v[220:223], v[184:187], v[40:43]
	s_waitcnt lgkmcnt(5)
	ds_read_b64_tr_b16 v[234:235], v145 offset:12800
	ds_read_b64_tr_b16 v[236:237], v146 offset:8192
	ds_read_b64_tr_b16 v[238:239], v146 offset:8704
	ds_read_b64_tr_b16 v[240:241], v146 offset:12288
	ds_read_b64_tr_b16 v[242:243], v146 offset:12800
	v_mfma_f32_16x16x32_bf16 v[40:43], v[224:227], v[188:191], v[40:43]
	s_waitcnt lgkmcnt(9)
	v_mfma_f32_16x16x32_bf16 v[44:47], v[220:223], v[192:195], v[44:47]
	s_waitcnt lgkmcnt(8)
	v_mfma_f32_16x16x32_bf16 v[44:47], v[224:227], v[196:199], v[44:47]
	s_waitcnt lgkmcnt(6)
	ds_read_b64_tr_b16 v[244:245], v147 offset:8192
	ds_read_b64_tr_b16 v[246:247], v147 offset:8704
	v_mfma_f32_16x16x32_bf16 v[48:51], v[228:231], v[184:187], v[48:51]
	s_waitcnt lgkmcnt(6)
	ds_read_b64_tr_b16 v[248:249], v147 offset:12288
	ds_read_b64_tr_b16 v[250:251], v147 offset:12800
	v_mfma_f32_16x16x32_bf16 v[48:51], v[232:235], v[188:191], v[48:51]
	v_mfma_f32_16x16x32_bf16 v[52:55], v[228:231], v[192:195], v[52:55]
	ds_read_b64_tr_b16 v[200:201], v144 offset:16384
	ds_read_b64_tr_b16 v[202:203], v144 offset:16896
	v_mfma_f32_16x16x32_bf16 v[52:55], v[232:235], v[196:199], v[52:55]
	s_waitcnt lgkmcnt(8)
	ds_read_b64_tr_b16 v[204:205], v144 offset:20480
	v_mfma_f32_16x16x32_bf16 v[56:59], v[236:239], v[184:187], v[56:59]
	s_waitcnt lgkmcnt(7)
	ds_read_b64_tr_b16 v[206:207], v144 offset:20992
	v_mfma_f32_16x16x32_bf16 v[56:59], v[240:243], v[188:191], v[56:59]
	v_mfma_f32_16x16x32_bf16 v[60:63], v[236:239], v[192:195], v[60:63]
	v_mfma_f32_16x16x32_bf16 v[60:63], v[240:243], v[196:199], v[60:63]
	s_waitcnt lgkmcnt(6)
	ds_read_b64_tr_b16 v[208:209], v145 offset:16384
	ds_read_b64_tr_b16 v[210:211], v145 offset:16896
	v_mfma_f32_16x16x32_bf16 v[64:67], v[244:247], v[184:187], v[64:67]
	s_waitcnt lgkmcnt(6)
	ds_read_b64_tr_b16 v[212:213], v145 offset:20480
	ds_read_b64_tr_b16 v[214:215], v145 offset:20992
	v_mfma_f32_16x16x32_bf16 v[64:67], v[248:251], v[188:191], v[64:67]
	v_mfma_f32_16x16x32_bf16 v[68:71], v[244:247], v[192:195], v[68:71]
	v_mfma_f32_16x16x32_bf16 v[68:71], v[248:251], v[196:199], v[68:71]
	s_waitcnt lgkmcnt(6)
	v_mfma_f32_16x16x32_bf16 v[72:75], v[200:203], v[184:187], v[72:75]
	s_waitcnt lgkmcnt(4)
	ds_read_b64_tr_b16 v[216:217], v146 offset:16384
	ds_read_b64_tr_b16 v[218:219], v146 offset:16896
	v_mfma_f32_16x16x32_bf16 v[72:75], v[204:207], v[188:191], v[72:75]
	ds_read_b64_tr_b16 v[220:221], v146 offset:20480
	v_mfma_f32_16x16x32_bf16 v[76:79], v[200:203], v[192:195], v[76:79]
	ds_read_b64_tr_b16 v[222:223], v146 offset:20992
	v_mfma_f32_16x16x32_bf16 v[76:79], v[204:207], v[196:199], v[76:79]
	s_waitcnt lgkmcnt(6)
	v_mfma_f32_16x16x32_bf16 v[80:83], v[208:211], v[184:187], v[80:83]
	s_waitcnt lgkmcnt(4)
	ds_read_b64_tr_b16 v[224:225], v147 offset:16384
	ds_read_b64_tr_b16 v[226:227], v147 offset:16896
	v_mfma_f32_16x16x32_bf16 v[80:83], v[212:215], v[188:191], v[80:83]
	s_barrier
	ds_read_b64_tr_b16 v[228:229], v147 offset:20480
	ds_read_b64_tr_b16 v[230:231], v147 offset:20992
	v_mfma_f32_16x16x32_bf16 v[84:87], v[208:211], v[192:195], v[84:87]
	v_mfma_f32_16x16x32_bf16 v[84:87], v[212:215], v[196:199], v[84:87]
	s_waitcnt lgkmcnt(6)
	ds_read_b128 v[104:107], v148 offset:0
	v_mfma_f32_16x16x32_bf16 v[88:91], v[216:219], v[184:187], v[88:91]
	s_waitcnt lgkmcnt(5)
	ds_read_b64_tr_b16 v[232:233], v150 offset:8192
	ds_read_b64_tr_b16 v[234:235], v150 offset:8704
	v_mfma_f32_16x16x32_bf16 v[88:91], v[220:223], v[188:191], v[88:91]
	v_mfma_f32_16x16x32_bf16 v[92:95], v[216:219], v[192:195], v[92:95]
	ds_read_b128 v[108:111], v149 offset:0
	v_mfma_f32_16x16x32_bf16 v[92:95], v[220:223], v[196:199], v[92:95]
	s_waitcnt lgkmcnt(6)
	ds_read_b64_tr_b16 v[236:237], v150 offset:12288
	ds_read_b64_tr_b16 v[238:239], v150 offset:12800
	v_mfma_f32_16x16x32_bf16 v[96:99], v[224:227], v[184:187], v[96:99]
	s_waitcnt lgkmcnt(6)
	ds_read_b128 v[112:115], v148 offset:2048
	v_mfma_f32_16x16x32_bf16 v[96:99], v[228:231], v[188:191], v[96:99]
	ds_read_b128 v[116:119], v149 offset:2048
	v_mfma_f32_16x16x32_bf16 v[100:103], v[224:227], v[192:195], v[100:103]
	ds_read_b64_tr_b16 v[240:241], v151 offset:8192
	v_mfma_f32_16x16x32_bf16 v[100:103], v[228:231], v[196:199], v[100:103]
	s_waitcnt lgkmcnt(6)
	ds_read_b64_tr_b16 v[242:243], v151 offset:8704
	ds_read_b64_tr_b16 v[244:245], v151 offset:12288
	v_mfma_f32_16x16x32_bf16 v[40:43], v[232:235], v[104:107], v[40:43]
	s_waitcnt lgkmcnt(5)
	ds_read_b64_tr_b16 v[246:247], v151 offset:12800
	ds_read_b64_tr_b16 v[248:249], v152 offset:8192
	ds_read_b64_tr_b16 v[250:251], v152 offset:8704
	ds_read_b64_tr_b16 v[200:201], v152 offset:12288
	ds_read_b64_tr_b16 v[202:203], v152 offset:12800
	v_mfma_f32_16x16x32_bf16 v[40:43], v[236:239], v[108:111], v[40:43]
	s_waitcnt lgkmcnt(9)
	v_mfma_f32_16x16x32_bf16 v[44:47], v[232:235], v[112:115], v[44:47]
	s_waitcnt lgkmcnt(8)
	v_mfma_f32_16x16x32_bf16 v[44:47], v[236:239], v[116:119], v[44:47]
	s_waitcnt lgkmcnt(6)
	ds_read_b64_tr_b16 v[204:205], v153 offset:8192
	ds_read_b64_tr_b16 v[206:207], v153 offset:8704
	v_mfma_f32_16x16x32_bf16 v[48:51], v[240:243], v[104:107], v[48:51]
	s_waitcnt lgkmcnt(6)
	ds_read_b64_tr_b16 v[208:209], v153 offset:12288
	ds_read_b64_tr_b16 v[210:211], v153 offset:12800
	v_mfma_f32_16x16x32_bf16 v[48:51], v[244:247], v[108:111], v[48:51]
	v_mfma_f32_16x16x32_bf16 v[52:55], v[240:243], v[112:115], v[52:55]
	ds_read_b64_tr_b16 v[212:213], v150 offset:16384
	ds_read_b64_tr_b16 v[214:215], v150 offset:16896
	v_mfma_f32_16x16x32_bf16 v[52:55], v[244:247], v[116:119], v[52:55]
	s_waitcnt lgkmcnt(8)
	ds_read_b64_tr_b16 v[216:217], v150 offset:20480
	v_mfma_f32_16x16x32_bf16 v[56:59], v[248:251], v[104:107], v[56:59]
	s_waitcnt lgkmcnt(7)
	ds_read_b64_tr_b16 v[218:219], v150 offset:20992
	v_mfma_f32_16x16x32_bf16 v[56:59], v[200:203], v[108:111], v[56:59]
	v_mfma_f32_16x16x32_bf16 v[60:63], v[248:251], v[112:115], v[60:63]
	v_mfma_f32_16x16x32_bf16 v[60:63], v[200:203], v[116:119], v[60:63]
	s_waitcnt lgkmcnt(6)
	ds_read_b64_tr_b16 v[220:221], v151 offset:16384
	ds_read_b64_tr_b16 v[222:223], v151 offset:16896
	v_mfma_f32_16x16x32_bf16 v[64:67], v[204:207], v[104:107], v[64:67]
	s_waitcnt lgkmcnt(6)
	ds_read_b64_tr_b16 v[224:225], v151 offset:20480
	ds_read_b64_tr_b16 v[226:227], v151 offset:20992
	v_mfma_f32_16x16x32_bf16 v[64:67], v[208:211], v[108:111], v[64:67]
	v_mfma_f32_16x16x32_bf16 v[68:71], v[204:207], v[112:115], v[68:71]
	v_mfma_f32_16x16x32_bf16 v[68:71], v[208:211], v[116:119], v[68:71]
	s_waitcnt lgkmcnt(6)
	v_mfma_f32_16x16x32_bf16 v[72:75], v[212:215], v[104:107], v[72:75]
	s_waitcnt lgkmcnt(4)
	ds_read_b64_tr_b16 v[228:229], v152 offset:16384
	ds_read_b64_tr_b16 v[230:231], v152 offset:16896
	v_mfma_f32_16x16x32_bf16 v[72:75], v[216:219], v[108:111], v[72:75]
	ds_read_b64_tr_b16 v[232:233], v152 offset:20480
	v_mfma_f32_16x16x32_bf16 v[76:79], v[212:215], v[112:115], v[76:79]
	ds_read_b64_tr_b16 v[234:235], v152 offset:20992
	v_mfma_f32_16x16x32_bf16 v[76:79], v[216:219], v[116:119], v[76:79]
	s_waitcnt lgkmcnt(6)
	v_mfma_f32_16x16x32_bf16 v[80:83], v[220:223], v[104:107], v[80:83]
	s_waitcnt lgkmcnt(4)
	ds_read_b64_tr_b16 v[236:237], v153 offset:16384
	ds_read_b64_tr_b16 v[238:239], v153 offset:16896
	v_mfma_f32_16x16x32_bf16 v[80:83], v[224:227], v[108:111], v[80:83]
	s_barrier
	ds_read_b64_tr_b16 v[240:241], v153 offset:20480
	ds_read_b64_tr_b16 v[242:243], v153 offset:20992
	v_mfma_f32_16x16x32_bf16 v[84:87], v[220:223], v[112:115], v[84:87]
	v_mfma_f32_16x16x32_bf16 v[84:87], v[224:227], v[116:119], v[84:87]
	s_waitcnt lgkmcnt(6)
	ds_read_b128 v[184:187], v154 offset:0
	v_mfma_f32_16x16x32_bf16 v[88:91], v[228:231], v[104:107], v[88:91]
	s_waitcnt lgkmcnt(5)
	ds_read_b64_tr_b16 v[244:245], v156 offset:8192
	ds_read_b64_tr_b16 v[246:247], v156 offset:8704
	v_mfma_f32_16x16x32_bf16 v[88:91], v[232:235], v[108:111], v[88:91]
	v_mfma_f32_16x16x32_bf16 v[92:95], v[228:231], v[112:115], v[92:95]
	ds_read_b128 v[188:191], v155 offset:0
	v_mfma_f32_16x16x32_bf16 v[92:95], v[232:235], v[116:119], v[92:95]
	s_waitcnt lgkmcnt(6)
	ds_read_b64_tr_b16 v[248:249], v156 offset:12288
	ds_read_b64_tr_b16 v[250:251], v156 offset:12800
	v_mfma_f32_16x16x32_bf16 v[96:99], v[236:239], v[104:107], v[96:99]
	s_waitcnt lgkmcnt(6)
	ds_read_b128 v[192:195], v154 offset:2048
	v_mfma_f32_16x16x32_bf16 v[96:99], v[240:243], v[108:111], v[96:99]
	ds_read_b128 v[196:199], v155 offset:2048
	v_mfma_f32_16x16x32_bf16 v[100:103], v[236:239], v[112:115], v[100:103]
	ds_read_b64_tr_b16 v[200:201], v157 offset:8192
	v_mfma_f32_16x16x32_bf16 v[100:103], v[240:243], v[116:119], v[100:103]
	s_waitcnt lgkmcnt(6)
	ds_read_b64_tr_b16 v[202:203], v157 offset:8704
	ds_read_b64_tr_b16 v[204:205], v157 offset:12288
	v_mfma_f32_16x16x32_bf16 v[40:43], v[244:247], v[184:187], v[40:43]
	s_waitcnt lgkmcnt(5)
	ds_read_b64_tr_b16 v[206:207], v157 offset:12800
	ds_read_b64_tr_b16 v[208:209], v158 offset:8192
	ds_read_b64_tr_b16 v[210:211], v158 offset:8704
	ds_read_b64_tr_b16 v[212:213], v158 offset:12288
	ds_read_b64_tr_b16 v[214:215], v158 offset:12800
	v_mfma_f32_16x16x32_bf16 v[40:43], v[248:251], v[188:191], v[40:43]
	s_waitcnt lgkmcnt(9)
	s_nop 0
	v_mfma_f32_16x16x32_bf16 v[44:47], v[244:247], v[192:195], v[44:47]
	s_waitcnt lgkmcnt(8)
	v_mfma_f32_16x16x32_bf16 v[44:47], v[248:251], v[196:199], v[44:47]
	s_waitcnt lgkmcnt(6)
	ds_read_b64_tr_b16 v[216:217], v159 offset:8192
	ds_read_b64_tr_b16 v[218:219], v159 offset:8704
	v_mul_f32 v40, s21, v40
	v_mul_f32 v41, s21, v41
	v_mul_f32 v42, s21, v42
	v_mul_f32 v43, s21, v43
	v_mfma_f32_16x16x32_bf16 v[48:51], v[200:203], v[184:187], v[48:51]
	s_waitcnt lgkmcnt(6)
	ds_read_b64_tr_b16 v[220:221], v159 offset:12288
	ds_read_b64_tr_b16 v[222:223], v159 offset:12800
	v_cvt_pk_bf16_f32 v104, v40, v41
	v_mfma_f32_16x16x32_bf16 v[48:51], v[204:207], v[188:191], v[48:51]
	v_cvt_pk_bf16_f32 v105, v42, v43
	v_mul_f32 v44, s21, v44
	v_mfma_f32_16x16x32_bf16 v[52:55], v[200:203], v[192:195], v[52:55]
	ds_read_b64_tr_b16 v[224:225], v156 offset:16384
	ds_read_b64_tr_b16 v[226:227], v156 offset:16896
	v_mfma_f32_16x16x32_bf16 v[52:55], v[204:207], v[196:199], v[52:55]
	s_waitcnt lgkmcnt(8)
	ds_read_b64_tr_b16 v[228:229], v156 offset:20480
	v_mul_f32 v48, s21, v48
	v_mfma_f32_16x16x32_bf16 v[56:59], v[208:211], v[184:187], v[56:59]
	s_waitcnt lgkmcnt(7)
	ds_read_b64_tr_b16 v[230:231], v156 offset:20992
	v_mul_f32 v49, s21, v49
	v_mfma_f32_16x16x32_bf16 v[56:59], v[212:215], v[188:191], v[56:59]
	v_mul_f32 v50, s21, v50
	v_mul_f32 v51, s21, v51
	v_mfma_f32_16x16x32_bf16 v[60:63], v[208:211], v[192:195], v[60:63]
	ds_read_b64_tr_b16 v[232:233], v157 offset:16384
	ds_read_b64_tr_b16 v[234:235], v157 offset:16896
	v_mfma_f32_16x16x32_bf16 v[60:63], v[212:215], v[196:199], v[60:63]
	s_waitcnt lgkmcnt(8)
	ds_read_b64_tr_b16 v[236:237], v157 offset:20480
	v_cvt_pk_bf16_f32 v106, v48, v49
	v_mfma_f32_16x16x32_bf16 v[64:67], v[216:219], v[184:187], v[64:67]
	s_waitcnt lgkmcnt(7)
	ds_read_b64_tr_b16 v[238:239], v157 offset:20992
	v_cvt_pk_bf16_f32 v107, v50, v51
	v_mfma_f32_16x16x32_bf16 v[64:67], v[220:223], v[188:191], v[64:67]
	v_mul_f32 v45, s21, v45
	v_mul_f32 v46, s21, v46
	v_mfma_f32_16x16x32_bf16 v[68:71], v[216:219], v[192:195], v[68:71]
	v_mul_f32 v47, s21, v47
	v_permlane16_swap_b32 v104, v106
	v_mfma_f32_16x16x32_bf16 v[68:71], v[220:223], v[196:199], v[68:71]
	s_waitcnt lgkmcnt(6)
	v_permlane16_swap_b32 v105, v107
	v_mul_f32 v52, s21, v52
	v_mfma_f32_16x16x32_bf16 v[72:75], v[224:227], v[184:187], v[72:75]
	s_waitcnt lgkmcnt(4)
	ds_read_b64_tr_b16 v[240:241], v158 offset:16384
	ds_read_b64_tr_b16 v[242:243], v158 offset:16896
	v_mfma_f32_16x16x32_bf16 v[72:75], v[228:231], v[188:191], v[72:75]
	ds_read_b64_tr_b16 v[244:245], v158 offset:20480
	v_mul_f32 v53, s21, v53
	ds_read_b64_tr_b16 v[246:247], v158 offset:20992
	v_mfma_f32_16x16x32_bf16 v[76:79], v[224:227], v[192:195], v[76:79]
	v_mul_f32 v54, s21, v54
	v_mul_f32 v55, s21, v55
	v_mfma_f32_16x16x32_bf16 v[76:79], v[228:231], v[196:199], v[76:79]
	s_waitcnt lgkmcnt(6)
	v_cvt_pk_bf16_f32 v108, v44, v45
	v_cvt_pk_bf16_f32 v109, v46, v47
	v_mfma_f32_16x16x32_bf16 v[80:83], v[232:235], v[184:187], v[80:83]
	s_waitcnt lgkmcnt(4)
	ds_read_b64_tr_b16 v[248:249], v159 offset:16384
	ds_read_b64_tr_b16 v[250:251], v159 offset:16896
	v_mfma_f32_16x16x32_bf16 v[80:83], v[236:239], v[188:191], v[80:83]
	s_barrier
	ds_read_b64_tr_b16 v[200:201], v159 offset:20480
	ds_read_b64_tr_b16 v[202:203], v159 offset:20992
	v_mfma_f32_16x16x32_bf16 v[84:87], v[232:235], v[192:195], v[84:87]
	v_cvt_pk_bf16_f32 v110, v52, v53
	v_cvt_pk_bf16_f32 v111, v54, v55
	v_mfma_f32_16x16x32_bf16 v[84:87], v[236:239], v[196:199], v[84:87]
	s_waitcnt lgkmcnt(6)
	ds_read_b128 v[204:207], v20 offset:0
	v_permlane16_swap_b32 v108, v110
	v_mfma_f32_16x16x32_bf16 v[88:91], v[240:243], v[184:187], v[88:91]
	s_waitcnt lgkmcnt(5)
	v_permlane16_swap_b32 v109, v111
	v_mul_f32 v56, s21, v56
	v_mfma_f32_16x16x32_bf16 v[88:91], v[244:247], v[188:191], v[88:91]
	ds_read_b128 v[208:211], v20 offset:2048
	v_mul_f32 v57, s21, v57
	v_mfma_f32_16x16x32_bf16 v[92:95], v[240:243], v[192:195], v[92:95]
	v_mul_f32 v58, s21, v58
	v_mul_f32 v59, s21, v59
	v_mfma_f32_16x16x32_bf16 v[92:95], v[244:247], v[196:199], v[92:95]
	s_waitcnt lgkmcnt(4)
	v_mul_f32 v64, s21, v64
	v_mul_f32 v65, s21, v65
	v_mfma_f32_16x16x32_bf16 v[96:99], v[248:251], v[184:187], v[96:99]
	s_waitcnt lgkmcnt(2)
	v_mul_f32 v66, s21, v66
	v_mul_f32 v67, s21, v67
	v_cvt_pk_bf16_f32 v112, v56, v57
	v_cvt_pk_bf16_f32 v113, v58, v59
	v_cvt_pk_bf16_f32 v114, v64, v65
	v_mfma_f32_16x16x32_bf16 v[96:99], v[200:203], v[188:191], v[96:99]
	ds_read_b128 v[212:215], v21 offset:0
	v_cvt_pk_bf16_f32 v115, v66, v67
	v_mfma_f32_16x16x32_bf16 v[100:103], v[248:251], v[192:195], v[100:103]
	v_mul_f32 v60, s21, v60
	v_mul_f32 v61, s21, v61
	v_mfma_f32_16x16x32_bf16 v[100:103], v[200:203], v[196:199], v[100:103]
	s_waitcnt lgkmcnt(2)
	v_mul_f32 v62, s21, v62
	v_mul_f32 v63, s21, v63
	v_mfma_f32_16x16x32_bf16 v[136:139], v[204:207], v[104:107], v[168:171]
	ds_read_b128 v[216:219], v21 offset:2048
	v_permlane16_swap_b32 v112, v114
	v_mfma_f32_16x16x32_bf16 v[144:147], v[204:207], v[108:111], v[172:175]
	s_waitcnt lgkmcnt(2)
	v_permlane16_swap_b32 v113, v115
	v_mul_f32 v68, s21, v68
	v_mfma_f32_16x16x32_bf16 v[140:143], v[208:211], v[104:107], v[168:171]
	v_mul_f32 v69, s21, v69
	v_mul_f32 v70, s21, v70
	v_mfma_f32_16x16x32_bf16 v[148:151], v[208:211], v[108:111], v[172:175]
	s_waitcnt lgkmcnt(1)
	v_mul_f32 v71, s21, v71
	v_cvt_pk_bf16_f32 v116, v60, v61
	v_cvt_pk_bf16_f32 v117, v62, v63
	v_cvt_pk_bf16_f32 v118, v68, v69
	v_cvt_pk_bf16_f32 v119, v70, v71
	v_mul_f32 v72, s21, v72
	v_permlane16_swap_b32 v116, v118
	v_permlane16_swap_b32 v117, v119
	v_mfma_f32_16x16x32_bf16 v[136:139], v[212:215], v[112:115], v[136:139]
	v_mul_f32 v73, s21, v73
	v_mul_f32 v74, s21, v74
	v_mfma_f32_16x16x32_bf16 v[144:147], v[212:215], v[116:119], v[144:147]
	s_waitcnt lgkmcnt(0)
	ds_read_b128 v[220:223], v20 offset:4096
	v_mul_f32 v75, s21, v75
	v_mul_f32 v80, s21, v80
	v_mul_f32 v81, s21, v81
	v_mul_f32 v82, s21, v82
	v_mul_f32 v83, s21, v83
	v_mfma_f32_16x16x32_bf16 v[140:143], v[216:219], v[112:115], v[140:143]
	ds_read_b128 v[224:227], v20 offset:6144
	v_cvt_pk_bf16_f32 v120, v72, v73
	v_mfma_f32_16x16x32_bf16 v[148:151], v[216:219], v[116:119], v[148:151]
	s_waitcnt lgkmcnt(1)
	s_barrier
	v_cvt_pk_bf16_f32 v121, v74, v75
	v_cvt_pk_bf16_f32 v122, v80, v81
	v_cvt_pk_bf16_f32 v123, v82, v83
	v_mul_f32 v76, s21, v76
	v_permlane16_swap_b32 v120, v122
	v_permlane16_swap_b32 v121, v123
	v_mul_f32 v77, s21, v77
	v_mul_f32 v78, s21, v78
	v_mul_f32 v79, s21, v79
	v_mul_f32 v84, s21, v84
	v_mul_f32 v85, s21, v85
	v_mul_f32 v86, s21, v86
	v_mul_f32 v87, s21, v87
	v_cvt_pk_bf16_f32 v124, v76, v77
	v_cvt_pk_bf16_f32 v125, v78, v79
	v_cvt_pk_bf16_f32 v126, v84, v85
	v_cvt_pk_bf16_f32 v127, v86, v87
	v_mfma_f32_16x16x32_bf16 v[136:139], v[220:223], v[120:123], v[136:139]
	v_permlane16_swap_b32 v124, v126
	v_permlane16_swap_b32 v125, v127
	v_mul_f32 v88, s21, v88
	v_mul_f32 v89, s21, v89
	v_mfma_f32_16x16x32_bf16 v[144:147], v[220:223], v[124:127], v[144:147]
	s_waitcnt lgkmcnt(0)
	ds_read_b128 v[228:231], v21 offset:4096
	v_mul_f32 v90, s21, v90
	v_mfma_f32_16x16x32_bf16 v[140:143], v[224:227], v[120:123], v[140:143]
	v_mul_f32 v91, s21, v91
	v_mul_f32 v96, s21, v96
	v_mfma_f32_16x16x32_bf16 v[148:151], v[224:227], v[124:127], v[148:151]
	s_waitcnt lgkmcnt(0)
	ds_read_b128 v[232:235], v21 offset:6144
	v_mul_f32 v97, s21, v97
	v_mul_f32 v98, s21, v98
	ds_read_b128 v[236:239], v20 offset:8192
	v_mul_f32 v99, s21, v99
	v_cvt_pk_bf16_f32 v128, v88, v89
	v_cvt_pk_bf16_f32 v129, v90, v91
	v_cvt_pk_bf16_f32 v130, v96, v97
	ds_read_b128 v[240:243], v20 offset:10240
	v_cvt_pk_bf16_f32 v131, v98, v99
	v_mul_f32 v92, s21, v92
	v_mul_f32 v93, s21, v93
	v_mul_f32 v94, s21, v94
	v_mul_f32 v95, s21, v95
	v_permlane16_swap_b32 v128, v130
	v_permlane16_swap_b32 v129, v131
	v_mul_f32 v100, s21, v100
	v_mul_f32 v101, s21, v101
	v_mul_f32 v102, s21, v102
	v_mul_f32 v103, s21, v103
	v_cvt_pk_bf16_f32 v132, v92, v93
	v_cvt_pk_bf16_f32 v133, v94, v95
	v_cvt_pk_bf16_f32 v134, v100, v101
	v_cvt_pk_bf16_f32 v135, v102, v103
	ds_read_b128 v[244:247], v21 offset:8192
	v_permlane16_swap_b32 v132, v134
	v_permlane16_swap_b32 v133, v135
	v_mfma_f32_16x16x32_bf16 v[136:139], v[228:231], v[128:131], v[136:139]
	ds_read_b128 v[248:251], v21 offset:10240
	v_mfma_f32_16x16x32_bf16 v[144:147], v[228:231], v[132:135], v[144:147]
	s_waitcnt lgkmcnt(4)
	v_mfma_f32_16x16x32_bf16 v[140:143], v[232:235], v[128:131], v[140:143]
	ds_read_b128 v[200:203], v20 offset:12288
	v_mfma_f32_16x16x32_bf16 v[148:151], v[232:235], v[132:135], v[148:151]
	s_waitcnt lgkmcnt(4)
	s_waitcnt vmcnt(0)
	v_exp_f32 v136, v136
	v_mfma_f32_16x16x32_bf16 v[152:155], v[236:239], v[104:107], v[168:171]
	ds_read_b128 v[204:207], v20 offset:14336
	v_mfma_f32_16x16x32_bf16 v[160:163], v[236:239], v[108:111], v[172:175]
	s_waitcnt lgkmcnt(4)
	v_exp_f32 v137, v137
	v_mfma_f32_16x16x32_bf16 v[156:159], v[240:243], v[104:107], v[168:171]
	ds_read_b128 v[208:211], v21 offset:12288
	v_cvt_pk_bf16_f32 v184, v136, v137
	v_mfma_f32_16x16x32_bf16 v[164:167], v[240:243], v[108:111], v[172:175]
	s_waitcnt lgkmcnt(4)
	v_exp_f32 v138, v138
	v_mfma_f32_16x16x32_bf16 v[152:155], v[244:247], v[112:115], v[152:155]
	ds_read_b128 v[212:215], v21 offset:14336
	v_mfma_f32_16x16x32_bf16 v[160:163], v[244:247], v[116:119], v[160:163]
	s_waitcnt lgkmcnt(4)
	v_exp_f32 v139, v139
	v_mfma_f32_16x16x32_bf16 v[156:159], v[248:251], v[112:115], v[156:159]
	v_exp_f32 v140, v140
	v_mfma_f32_16x16x32_bf16 v[164:167], v[248:251], v[116:119], v[164:167]
	s_waitcnt lgkmcnt(3)
	v_exp_f32 v141, v141
	v_mfma_f32_16x16x32_bf16 v[152:155], v[200:203], v[120:123], v[152:155]
	v_exp_f32 v142, v142
	v_mfma_f32_16x16x32_bf16 v[160:163], v[200:203], v[124:127], v[160:163]
	s_waitcnt lgkmcnt(2)
	v_exp_f32 v143, v143
	v_mfma_f32_16x16x32_bf16 v[156:159], v[204:207], v[120:123], v[156:159]
	v_cvt_pk_bf16_f32 v185, v138, v139
	v_cvt_pk_bf16_f32 v186, v140, v141
	v_mfma_f32_16x16x32_bf16 v[164:167], v[204:207], v[124:127], v[164:167]
	s_waitcnt lgkmcnt(1)
	ds_read_b64_tr_b16 v[216:217], v8 offset:16384
	ds_read_b64_tr_b16 v[218:219], v8 offset:18432
	v_mfma_f32_16x16x32_bf16 v[152:155], v[208:211], v[128:131], v[152:155]
	v_cvt_pk_bf16_f32 v187, v142, v143
	v_mfma_f32_16x16x32_bf16 v[160:163], v[208:211], v[132:135], v[160:163]
	s_waitcnt lgkmcnt(2)
	ds_read_b64_tr_b16 v[220:221], v10 offset:16384
	ds_read_b64_tr_b16 v[222:223], v10 offset:18432
	v_mfma_f32_16x16x32_bf16 v[156:159], v[212:215], v[128:131], v[156:159]
	v_exp_f32 v144, v144
	v_mfma_f32_16x16x32_bf16 v[164:167], v[212:215], v[132:135], v[164:167]
	s_waitcnt lgkmcnt(2)
	ds_read_b64_tr_b16 v[224:225], v8 offset:20480
	ds_read_b64_tr_b16 v[226:227], v8 offset:22528
	v_exp_f32 v145, v145
	ds_read_b64_tr_b16 v[228:229], v10 offset:20480
	v_exp_f32 v146, v146
	ds_read_b64_tr_b16 v[230:231], v10 offset:22528
	v_exp_f32 v147, v147
	v_exp_f32 v148, v148
	v_exp_f32 v149, v149
	v_exp_f32 v150, v150
	v_exp_f32 v151, v151
	v_cvt_pk_bf16_f32 v188, v144, v145
	v_cvt_pk_bf16_f32 v189, v146, v147
	v_cvt_pk_bf16_f32 v190, v148, v149
	v_cvt_pk_bf16_f32 v191, v150, v151
	v_mfma_f32_16x16x32_bf16 v[40:43], v[216:219], v[184:187], 0
	v_exp_f32 v152, v152
	v_mfma_f32_16x16x32_bf16 v[48:51], v[216:219], v[188:191], 0
	s_waitcnt lgkmcnt(4)
	v_exp_f32 v153, v153
	v_mfma_f32_16x16x32_bf16 v[56:59], v[220:223], v[184:187], 0
	ds_read_b64_tr_b16 v[232:233], v9 offset:16384
	ds_read_b64_tr_b16 v[234:235], v9 offset:18432
	v_mfma_f32_16x16x32_bf16 v[64:67], v[220:223], v[188:191], 0
	s_waitcnt lgkmcnt(4)
	v_exp_f32 v154, v154
	v_mfma_f32_16x16x32_bf16 v[72:75], v[224:227], v[184:187], 0
	ds_read_b64_tr_b16 v[236:237], v11 offset:16384
	ds_read_b64_tr_b16 v[238:239], v11 offset:18432
	v_mfma_f32_16x16x32_bf16 v[80:83], v[224:227], v[188:191], 0
	s_waitcnt lgkmcnt(4)
	v_exp_f32 v155, v155
	v_mfma_f32_16x16x32_bf16 v[88:91], v[228:231], v[184:187], 0
	ds_read_b64_tr_b16 v[240:241], v9 offset:20480
	ds_read_b64_tr_b16 v[242:243], v9 offset:22528
	v_mfma_f32_16x16x32_bf16 v[96:99], v[228:231], v[188:191], 0
	v_exp_f32 v156, v156
	v_mfma_f32_16x16x32_bf16 v[176:179], v[252:255], v[184:187], 0
	ds_read_b64_tr_b16 v[244:245], v11 offset:20480
	ds_read_b64_tr_b16 v[246:247], v11 offset:22528
	v_mfma_f32_16x16x32_bf16 v[180:183], v[252:255], v[188:191], 0
	s_waitcnt lgkmcnt(6)
	s_barrier
	ds_read_b128 v[248:251], v20 offset:24576
	v_mfma_f32_16x16x32_bf16 v[44:47], v[232:235], v[184:187], 0
	ds_read_b128 v[200:203], v20 offset:26624
	v_cvt_pk_bf16_f32 v192, v152, v153
	v_mfma_f32_16x16x32_bf16 v[52:55], v[232:235], v[188:191], 0
	s_waitcnt lgkmcnt(6)
	v_exp_f32 v157, v157
	v_mfma_f32_16x16x32_bf16 v[60:63], v[236:239], v[184:187], 0
	ds_read_b128 v[204:207], v21 offset:24576
	v_cvt_pk_bf16_f32 v193, v154, v155
	v_mfma_f32_16x16x32_bf16 v[68:71], v[236:239], v[188:191], 0
	s_waitcnt lgkmcnt(5)
	v_exp_f32 v158, v158
	v_mfma_f32_16x16x32_bf16 v[76:79], v[240:243], v[184:187], 0
	ds_read_b128 v[208:211], v21 offset:26624
	v_cvt_pk_bf16_f32 v194, v156, v157
	v_mfma_f32_16x16x32_bf16 v[84:87], v[240:243], v[188:191], 0
	s_waitcnt lgkmcnt(4)
	v_exp_f32 v159, v159
	v_mfma_f32_16x16x32_bf16 v[92:95], v[244:247], v[184:187], 0
	ds_read_b128 v[212:215], v20 offset:28672
	v_cvt_pk_bf16_f32 v195, v158, v159
	v_mfma_f32_16x16x32_bf16 v[100:103], v[244:247], v[188:191], 0
	s_waitcnt lgkmcnt(4)
	v_exp_f32 v160, v160
	v_mfma_f32_16x16x32_bf16 v[136:139], v[248:251], v[104:107], v[168:171]
	ds_read_b128 v[216:219], v20 offset:30720
	v_mfma_f32_16x16x32_bf16 v[144:147], v[248:251], v[108:111], v[172:175]
	s_waitcnt lgkmcnt(4)
	v_exp_f32 v161, v161
	v_mfma_f32_16x16x32_bf16 v[140:143], v[200:203], v[104:107], v[168:171]
	ds_read_b128 v[220:223], v21 offset:28672
	v_cvt_pk_bf16_f32 v196, v160, v161
	v_mfma_f32_16x16x32_bf16 v[148:151], v[200:203], v[108:111], v[172:175]
	s_waitcnt lgkmcnt(4)
	v_exp_f32 v162, v162
	v_mfma_f32_16x16x32_bf16 v[136:139], v[204:207], v[112:115], v[136:139]
	ds_read_b128 v[224:227], v21 offset:30720
	v_mfma_f32_16x16x32_bf16 v[144:147], v[204:207], v[116:119], v[144:147]
	s_waitcnt lgkmcnt(4)
	v_exp_f32 v163, v163
	v_mfma_f32_16x16x32_bf16 v[140:143], v[208:211], v[112:115], v[140:143]
	ds_read_b64_tr_b16 v[228:229], v8 offset:32768
	ds_read_b64_tr_b16 v[230:231], v8 offset:34816
	v_mfma_f32_16x16x32_bf16 v[148:151], v[208:211], v[116:119], v[148:151]
	s_waitcnt lgkmcnt(5)
	v_exp_f32 v164, v164
	v_mfma_f32_16x16x32_bf16 v[136:139], v[212:215], v[120:123], v[136:139]
	ds_read_b64_tr_b16 v[232:233], v10 offset:32768
	ds_read_b64_tr_b16 v[234:235], v10 offset:34816
	v_mfma_f32_16x16x32_bf16 v[144:147], v[212:215], v[124:127], v[144:147]
	s_waitcnt lgkmcnt(6)
	v_exp_f32 v165, v165
	v_mfma_f32_16x16x32_bf16 v[140:143], v[216:219], v[120:123], v[140:143]
	ds_read_b64_tr_b16 v[236:237], v8 offset:36864
	ds_read_b64_tr_b16 v[238:239], v8 offset:38912
	v_mfma_f32_16x16x32_bf16 v[148:151], v[216:219], v[124:127], v[148:151]
	s_waitcnt lgkmcnt(7)
	v_exp_f32 v166, v166
	v_mfma_f32_16x16x32_bf16 v[136:139], v[220:223], v[128:131], v[136:139]
	ds_read_b64_tr_b16 v[240:241], v10 offset:36864
	ds_read_b64_tr_b16 v[242:243], v10 offset:38912
	v_mfma_f32_16x16x32_bf16 v[144:147], v[220:223], v[132:135], v[144:147]
	s_waitcnt lgkmcnt(8)
	v_exp_f32 v167, v167
	v_mfma_f32_16x16x32_bf16 v[140:143], v[224:227], v[128:131], v[140:143]
	v_cvt_pk_bf16_f32 v197, v162, v163
	v_cvt_pk_bf16_f32 v198, v164, v165
	v_mfma_f32_16x16x32_bf16 v[148:151], v[224:227], v[132:135], v[148:151]
	s_waitcnt lgkmcnt(6)
	v_cvt_pk_bf16_f32 v199, v166, v167
	v_mfma_f32_16x16x32_bf16 v[40:43], v[228:231], v[192:195], v[40:43]
	v_exp_f32 v136, v136
	v_mfma_f32_16x16x32_bf16 v[48:51], v[228:231], v[196:199], v[48:51]
	s_waitcnt lgkmcnt(4)
	v_exp_f32 v137, v137
	v_mfma_f32_16x16x32_bf16 v[56:59], v[232:235], v[192:195], v[56:59]
	ds_read_b64_tr_b16 v[244:245], v9 offset:32768
	ds_read_b64_tr_b16 v[246:247], v9 offset:34816
	v_mfma_f32_16x16x32_bf16 v[64:67], v[232:235], v[196:199], v[64:67]
	s_waitcnt lgkmcnt(4)
	v_exp_f32 v138, v138
	v_mfma_f32_16x16x32_bf16 v[72:75], v[236:239], v[192:195], v[72:75]
	ds_read_b64_tr_b16 v[248:249], v11 offset:32768
	ds_read_b64_tr_b16 v[250:251], v11 offset:34816
	v_mfma_f32_16x16x32_bf16 v[80:83], v[236:239], v[196:199], v[80:83]
	s_waitcnt lgkmcnt(4)
	v_exp_f32 v139, v139
	v_mfma_f32_16x16x32_bf16 v[88:91], v[240:243], v[192:195], v[88:91]
	ds_read_b64_tr_b16 v[200:201], v9 offset:36864
	ds_read_b64_tr_b16 v[202:203], v9 offset:38912
	v_mfma_f32_16x16x32_bf16 v[96:99], v[240:243], v[196:199], v[96:99]
	v_exp_f32 v140, v140
	v_mfma_f32_16x16x32_bf16 v[176:179], v[252:255], v[192:195], v[176:179]
	ds_read_b64_tr_b16 v[204:205], v11 offset:36864
	ds_read_b64_tr_b16 v[206:207], v11 offset:38912
	v_mfma_f32_16x16x32_bf16 v[180:183], v[252:255], v[196:199], v[180:183]
	s_waitcnt lgkmcnt(6)
	s_barrier
	ds_read_b128 v[208:211], v20 offset:40960
	v_mfma_f32_16x16x32_bf16 v[44:47], v[244:247], v[192:195], v[44:47]
	ds_read_b128 v[212:215], v20 offset:43008
	v_cvt_pk_bf16_f32 v184, v136, v137
	v_mfma_f32_16x16x32_bf16 v[52:55], v[244:247], v[196:199], v[52:55]
	s_waitcnt lgkmcnt(6)
	v_exp_f32 v141, v141
	v_mfma_f32_16x16x32_bf16 v[60:63], v[248:251], v[192:195], v[60:63]
	ds_read_b128 v[216:219], v21 offset:40960
	v_cvt_pk_bf16_f32 v185, v138, v139
	v_mfma_f32_16x16x32_bf16 v[68:71], v[248:251], v[196:199], v[68:71]
	s_waitcnt lgkmcnt(5)
	v_exp_f32 v142, v142
	v_mfma_f32_16x16x32_bf16 v[76:79], v[200:203], v[192:195], v[76:79]
	ds_read_b128 v[220:223], v21 offset:43008
	v_cvt_pk_bf16_f32 v186, v140, v141
	v_mfma_f32_16x16x32_bf16 v[84:87], v[200:203], v[196:199], v[84:87]
	s_waitcnt lgkmcnt(4)
	v_exp_f32 v143, v143
	v_mfma_f32_16x16x32_bf16 v[92:95], v[204:207], v[192:195], v[92:95]
	ds_read_b128 v[224:227], v20 offset:45056
	v_cvt_pk_bf16_f32 v187, v142, v143
	v_mfma_f32_16x16x32_bf16 v[100:103], v[204:207], v[196:199], v[100:103]
	s_waitcnt lgkmcnt(4)
	buffer_atomic_add v7, v6, s[24:27], 0 offen sc1
	v_mfma_f32_16x16x32_bf16 v[152:155], v[208:211], v[104:107], v[168:171]
	ds_read_b128 v[228:231], v20 offset:47104
	v_mfma_f32_16x16x32_bf16 v[160:163], v[208:211], v[108:111], v[172:175]
	s_waitcnt lgkmcnt(4)
	v_exp_f32 v144, v144
	v_mfma_f32_16x16x32_bf16 v[156:159], v[212:215], v[104:107], v[168:171]
	ds_read_b128 v[232:235], v21 offset:45056
	v_mfma_f32_16x16x32_bf16 v[164:167], v[212:215], v[108:111], v[172:175]
	s_waitcnt lgkmcnt(4)
	v_exp_f32 v145, v145
	v_mfma_f32_16x16x32_bf16 v[152:155], v[216:219], v[112:115], v[152:155]
	ds_read_b128 v[236:239], v21 offset:47104
	v_cvt_pk_bf16_f32 v188, v144, v145
	v_mfma_f32_16x16x32_bf16 v[160:163], v[216:219], v[116:119], v[160:163]
	s_waitcnt lgkmcnt(4)
	v_exp_f32 v146, v146
	v_mfma_f32_16x16x32_bf16 v[156:159], v[220:223], v[112:115], v[156:159]
	v_exp_f32 v147, v147
	v_mfma_f32_16x16x32_bf16 v[164:167], v[220:223], v[116:119], v[164:167]
	s_waitcnt lgkmcnt(3)
	ds_read_b64_tr_b16 v[240:241], v8 offset:49152
	ds_read_b64_tr_b16 v[242:243], v8 offset:51200
	v_mfma_f32_16x16x32_bf16 v[152:155], v[224:227], v[120:123], v[152:155]
	v_exp_f32 v148, v148
	v_mfma_f32_16x16x32_bf16 v[160:163], v[224:227], v[124:127], v[160:163]
	s_waitcnt lgkmcnt(4)
	ds_read_b64_tr_b16 v[244:245], v10 offset:49152
	ds_read_b64_tr_b16 v[246:247], v10 offset:51200
	v_mfma_f32_16x16x32_bf16 v[156:159], v[228:231], v[120:123], v[156:159]
	v_exp_f32 v149, v149
	v_mfma_f32_16x16x32_bf16 v[164:167], v[228:231], v[124:127], v[164:167]
	s_waitcnt lgkmcnt(5)
	ds_read_b64_tr_b16 v[248:249], v8 offset:53248
	ds_read_b64_tr_b16 v[250:251], v8 offset:55296
	v_mfma_f32_16x16x32_bf16 v[152:155], v[232:235], v[128:131], v[152:155]
	v_exp_f32 v150, v150
	v_mfma_f32_16x16x32_bf16 v[160:163], v[232:235], v[132:135], v[160:163]
	s_waitcnt lgkmcnt(6)
	ds_read_b64_tr_b16 v[200:201], v10 offset:53248
	ds_read_b64_tr_b16 v[202:203], v10 offset:55296
	v_mfma_f32_16x16x32_bf16 v[156:159], v[236:239], v[128:131], v[156:159]
	v_exp_f32 v151, v151
	v_mfma_f32_16x16x32_bf16 v[164:167], v[236:239], v[132:135], v[164:167]
	s_waitcnt lgkmcnt(6)
	v_cvt_pk_bf16_f32 v189, v146, v147
	v_cvt_pk_bf16_f32 v190, v148, v149
	v_cvt_pk_bf16_f32 v191, v150, v151
	v_mfma_f32_16x16x32_bf16 v[40:43], v[240:243], v[184:187], v[40:43]
	v_exp_f32 v152, v152
	v_mfma_f32_16x16x32_bf16 v[48:51], v[240:243], v[188:191], v[48:51]
	s_waitcnt lgkmcnt(4)
	v_exp_f32 v153, v153
	v_mfma_f32_16x16x32_bf16 v[56:59], v[244:247], v[184:187], v[56:59]
	ds_read_b64_tr_b16 v[204:205], v9 offset:49152
	ds_read_b64_tr_b16 v[206:207], v9 offset:51200
	v_mfma_f32_16x16x32_bf16 v[64:67], v[244:247], v[188:191], v[64:67]
	s_waitcnt lgkmcnt(4)
	v_exp_f32 v154, v154
	v_mfma_f32_16x16x32_bf16 v[72:75], v[248:251], v[184:187], v[72:75]
	ds_read_b64_tr_b16 v[208:209], v11 offset:49152
	ds_read_b64_tr_b16 v[210:211], v11 offset:51200
	v_mfma_f32_16x16x32_bf16 v[80:83], v[248:251], v[188:191], v[80:83]
	s_waitcnt lgkmcnt(4)
	v_exp_f32 v155, v155
	v_mfma_f32_16x16x32_bf16 v[88:91], v[200:203], v[184:187], v[88:91]
	ds_read_b64_tr_b16 v[212:213], v9 offset:53248
	ds_read_b64_tr_b16 v[214:215], v9 offset:55296
	v_mfma_f32_16x16x32_bf16 v[96:99], v[200:203], v[188:191], v[96:99]
	v_exp_f32 v156, v156
	v_mfma_f32_16x16x32_bf16 v[176:179], v[252:255], v[184:187], v[176:179]
	ds_read_b64_tr_b16 v[216:217], v11 offset:53248
	ds_read_b64_tr_b16 v[218:219], v11 offset:55296
	v_mfma_f32_16x16x32_bf16 v[180:183], v[252:255], v[188:191], v[180:183]
	s_waitcnt lgkmcnt(6)
	s_barrier
	ds_read_b128 v[220:223], v20 offset:57344
	v_mfma_f32_16x16x32_bf16 v[44:47], v[204:207], v[184:187], v[44:47]
	ds_read_b128 v[224:227], v20 offset:59392
	v_cvt_pk_bf16_f32 v192, v152, v153
	v_mfma_f32_16x16x32_bf16 v[52:55], v[204:207], v[188:191], v[52:55]
	s_waitcnt lgkmcnt(6)
	v_exp_f32 v157, v157
	v_mfma_f32_16x16x32_bf16 v[60:63], v[208:211], v[184:187], v[60:63]
	ds_read_b128 v[228:231], v21 offset:57344
	v_cvt_pk_bf16_f32 v193, v154, v155
	v_mfma_f32_16x16x32_bf16 v[68:71], v[208:211], v[188:191], v[68:71]
	s_waitcnt lgkmcnt(5)
	v_exp_f32 v158, v158
	v_mfma_f32_16x16x32_bf16 v[76:79], v[212:215], v[184:187], v[76:79]
	ds_read_b128 v[232:235], v21 offset:59392
	v_cvt_pk_bf16_f32 v194, v156, v157
	v_mfma_f32_16x16x32_bf16 v[84:87], v[212:215], v[188:191], v[84:87]
	s_waitcnt lgkmcnt(4)
	v_exp_f32 v159, v159
	v_mfma_f32_16x16x32_bf16 v[92:95], v[216:219], v[184:187], v[92:95]
	ds_read_b128 v[236:239], v20 offset:61440
	v_cvt_pk_bf16_f32 v195, v158, v159
	v_mfma_f32_16x16x32_bf16 v[100:103], v[216:219], v[188:191], v[100:103]
	s_waitcnt lgkmcnt(4)
	v_exp_f32 v160, v160
	v_mfma_f32_16x16x32_bf16 v[136:139], v[220:223], v[104:107], v[168:171]
	ds_read_b128 v[240:243], v20 offset:63488
	v_mfma_f32_16x16x32_bf16 v[144:147], v[220:223], v[108:111], v[172:175]
	s_waitcnt lgkmcnt(4)
	v_exp_f32 v161, v161
	v_mfma_f32_16x16x32_bf16 v[140:143], v[224:227], v[104:107], v[168:171]
	ds_read_b128 v[244:247], v21 offset:61440
	v_cvt_pk_bf16_f32 v196, v160, v161
	v_mfma_f32_16x16x32_bf16 v[148:151], v[224:227], v[108:111], v[172:175]
	s_waitcnt lgkmcnt(4)
	v_exp_f32 v162, v162
	v_mfma_f32_16x16x32_bf16 v[136:139], v[228:231], v[112:115], v[136:139]
	ds_read_b128 v[248:251], v21 offset:63488
	v_mfma_f32_16x16x32_bf16 v[144:147], v[228:231], v[116:119], v[144:147]
	s_waitcnt lgkmcnt(4)
	v_exp_f32 v163, v163
	v_mfma_f32_16x16x32_bf16 v[140:143], v[232:235], v[112:115], v[140:143]
	ds_read_b64_tr_b16 v[200:201], v12 offset:0
	ds_read_b64_tr_b16 v[202:203], v12 offset:2048
	v_mfma_f32_16x16x32_bf16 v[148:151], v[232:235], v[116:119], v[148:151]
	s_waitcnt lgkmcnt(5)
	v_exp_f32 v164, v164
	v_mfma_f32_16x16x32_bf16 v[136:139], v[236:239], v[120:123], v[136:139]
	ds_read_b64_tr_b16 v[204:205], v14 offset:0
	ds_read_b64_tr_b16 v[206:207], v14 offset:2048
	v_mfma_f32_16x16x32_bf16 v[144:147], v[236:239], v[124:127], v[144:147]
	s_waitcnt lgkmcnt(6)
	v_exp_f32 v165, v165
	v_mfma_f32_16x16x32_bf16 v[140:143], v[240:243], v[120:123], v[140:143]
	ds_read_b64_tr_b16 v[208:209], v12 offset:4096
	ds_read_b64_tr_b16 v[210:211], v12 offset:6144
	v_mfma_f32_16x16x32_bf16 v[148:151], v[240:243], v[124:127], v[148:151]
	s_waitcnt lgkmcnt(7)
	v_exp_f32 v166, v166
	v_mfma_f32_16x16x32_bf16 v[136:139], v[244:247], v[128:131], v[136:139]
	ds_read_b64_tr_b16 v[212:213], v14 offset:4096
	ds_read_b64_tr_b16 v[214:215], v14 offset:6144
	v_mfma_f32_16x16x32_bf16 v[144:147], v[244:247], v[132:135], v[144:147]
	s_waitcnt lgkmcnt(8)
	v_exp_f32 v167, v167
	v_mfma_f32_16x16x32_bf16 v[140:143], v[248:251], v[128:131], v[140:143]
	v_cvt_pk_bf16_f32 v197, v162, v163
	v_cvt_pk_bf16_f32 v198, v164, v165
	v_mfma_f32_16x16x32_bf16 v[148:151], v[248:251], v[132:135], v[148:151]
	s_waitcnt lgkmcnt(6)
	v_cvt_pk_bf16_f32 v199, v166, v167
	v_mfma_f32_16x16x32_bf16 v[40:43], v[200:203], v[192:195], v[40:43]
	v_exp_f32 v136, v136
	v_mfma_f32_16x16x32_bf16 v[48:51], v[200:203], v[196:199], v[48:51]
	s_waitcnt lgkmcnt(4)
	v_exp_f32 v137, v137
	v_mfma_f32_16x16x32_bf16 v[56:59], v[204:207], v[192:195], v[56:59]
	ds_read_b64_tr_b16 v[216:217], v13 offset:0
	ds_read_b64_tr_b16 v[218:219], v13 offset:2048
	v_mfma_f32_16x16x32_bf16 v[64:67], v[204:207], v[196:199], v[64:67]
	s_waitcnt lgkmcnt(4)
	v_exp_f32 v138, v138
	v_mfma_f32_16x16x32_bf16 v[72:75], v[208:211], v[192:195], v[72:75]
	ds_read_b64_tr_b16 v[220:221], v15 offset:0
	ds_read_b64_tr_b16 v[222:223], v15 offset:2048
	v_mfma_f32_16x16x32_bf16 v[80:83], v[208:211], v[196:199], v[80:83]
	s_waitcnt lgkmcnt(4)
	v_exp_f32 v139, v139
	v_mfma_f32_16x16x32_bf16 v[88:91], v[212:215], v[192:195], v[88:91]
	ds_read_b64_tr_b16 v[224:225], v13 offset:4096
	ds_read_b64_tr_b16 v[226:227], v13 offset:6144
	v_mfma_f32_16x16x32_bf16 v[96:99], v[212:215], v[196:199], v[96:99]
	v_exp_f32 v140, v140
	v_mfma_f32_16x16x32_bf16 v[176:179], v[252:255], v[192:195], v[176:179]
	ds_read_b64_tr_b16 v[228:229], v15 offset:4096
	ds_read_b64_tr_b16 v[230:231], v15 offset:6144
	v_mfma_f32_16x16x32_bf16 v[180:183], v[252:255], v[196:199], v[180:183]
	s_waitcnt lgkmcnt(6)
	s_barrier
	ds_read_b128 v[232:235], v22 offset:8192
	v_mfma_f32_16x16x32_bf16 v[44:47], v[216:219], v[192:195], v[44:47]
	ds_read_b128 v[236:239], v22 offset:10240
	v_cvt_pk_bf16_f32 v184, v136, v137
	v_mfma_f32_16x16x32_bf16 v[52:55], v[216:219], v[196:199], v[52:55]
	s_waitcnt lgkmcnt(6)
	v_exp_f32 v141, v141
	v_mfma_f32_16x16x32_bf16 v[60:63], v[220:223], v[192:195], v[60:63]
	ds_read_b128 v[240:243], v23 offset:8192
	v_cvt_pk_bf16_f32 v185, v138, v139
	v_mfma_f32_16x16x32_bf16 v[68:71], v[220:223], v[196:199], v[68:71]
	s_waitcnt lgkmcnt(5)
	v_exp_f32 v142, v142
	v_mfma_f32_16x16x32_bf16 v[76:79], v[224:227], v[192:195], v[76:79]
	ds_read_b128 v[244:247], v23 offset:10240
	v_cvt_pk_bf16_f32 v186, v140, v141
	v_mfma_f32_16x16x32_bf16 v[84:87], v[224:227], v[196:199], v[84:87]
	s_waitcnt lgkmcnt(4)
	v_exp_f32 v143, v143
	v_mfma_f32_16x16x32_bf16 v[92:95], v[228:231], v[192:195], v[92:95]
	ds_read_b128 v[248:251], v22 offset:12288
	v_cvt_pk_bf16_f32 v187, v142, v143
	v_mfma_f32_16x16x32_bf16 v[100:103], v[228:231], v[196:199], v[100:103]
	s_waitcnt lgkmcnt(4)
	v_exp_f32 v144, v144
	v_mfma_f32_16x16x32_bf16 v[152:155], v[232:235], v[104:107], v[168:171]
	ds_read_b128 v[200:203], v22 offset:14336
	v_mfma_f32_16x16x32_bf16 v[160:163], v[232:235], v[108:111], v[172:175]
	s_waitcnt lgkmcnt(4)
	v_exp_f32 v145, v145
	v_mfma_f32_16x16x32_bf16 v[156:159], v[236:239], v[104:107], v[168:171]
	ds_read_b128 v[204:207], v23 offset:12288
	v_cvt_pk_bf16_f32 v188, v144, v145
	v_mfma_f32_16x16x32_bf16 v[164:167], v[236:239], v[108:111], v[172:175]
	s_waitcnt lgkmcnt(4)
	v_exp_f32 v146, v146
	v_mfma_f32_16x16x32_bf16 v[152:155], v[240:243], v[112:115], v[152:155]
	ds_read_b128 v[208:211], v23 offset:14336
	v_mfma_f32_16x16x32_bf16 v[160:163], v[240:243], v[116:119], v[160:163]
	s_waitcnt lgkmcnt(4)
	v_exp_f32 v147, v147
	v_mfma_f32_16x16x32_bf16 v[156:159], v[244:247], v[112:115], v[156:159]
	ds_read_b64_tr_b16 v[212:213], v12 offset:16384
	ds_read_b64_tr_b16 v[214:215], v12 offset:18432
	v_mfma_f32_16x16x32_bf16 v[164:167], v[244:247], v[116:119], v[164:167]
	s_waitcnt lgkmcnt(5)
	v_exp_f32 v148, v148
	v_mfma_f32_16x16x32_bf16 v[152:155], v[248:251], v[120:123], v[152:155]
	ds_read_b64_tr_b16 v[216:217], v14 offset:16384
	ds_read_b64_tr_b16 v[218:219], v14 offset:18432
	v_mfma_f32_16x16x32_bf16 v[160:163], v[248:251], v[124:127], v[160:163]
	s_waitcnt lgkmcnt(6)
	v_exp_f32 v149, v149
	v_mfma_f32_16x16x32_bf16 v[156:159], v[200:203], v[120:123], v[156:159]
	ds_read_b64_tr_b16 v[220:221], v12 offset:20480
	ds_read_b64_tr_b16 v[222:223], v12 offset:22528
	v_mfma_f32_16x16x32_bf16 v[164:167], v[200:203], v[124:127], v[164:167]
	s_waitcnt lgkmcnt(7)
	v_exp_f32 v150, v150
	v_mfma_f32_16x16x32_bf16 v[152:155], v[204:207], v[128:131], v[152:155]
	ds_read_b64_tr_b16 v[224:225], v14 offset:20480
	ds_read_b64_tr_b16 v[226:227], v14 offset:22528
	v_mfma_f32_16x16x32_bf16 v[160:163], v[204:207], v[132:135], v[160:163]
	s_waitcnt lgkmcnt(8)
	v_exp_f32 v151, v151
	v_mfma_f32_16x16x32_bf16 v[156:159], v[208:211], v[128:131], v[156:159]
	v_cvt_pk_bf16_f32 v189, v146, v147
	v_cvt_pk_bf16_f32 v190, v148, v149
	v_mfma_f32_16x16x32_bf16 v[164:167], v[208:211], v[132:135], v[164:167]
	s_waitcnt lgkmcnt(6)
	v_cvt_pk_bf16_f32 v191, v150, v151
	v_mfma_f32_16x16x32_bf16 v[40:43], v[212:215], v[184:187], v[40:43]
	v_exp_f32 v152, v152
	v_mfma_f32_16x16x32_bf16 v[48:51], v[212:215], v[188:191], v[48:51]
	s_waitcnt lgkmcnt(4)
	v_exp_f32 v153, v153
	v_mfma_f32_16x16x32_bf16 v[56:59], v[216:219], v[184:187], v[56:59]
	ds_read_b64_tr_b16 v[228:229], v13 offset:16384
	ds_read_b64_tr_b16 v[230:231], v13 offset:18432
	v_mfma_f32_16x16x32_bf16 v[64:67], v[216:219], v[188:191], v[64:67]
	s_waitcnt lgkmcnt(4)
	v_exp_f32 v154, v154
	v_mfma_f32_16x16x32_bf16 v[72:75], v[220:223], v[184:187], v[72:75]
	ds_read_b64_tr_b16 v[232:233], v15 offset:16384
	ds_read_b64_tr_b16 v[234:235], v15 offset:18432
	v_mfma_f32_16x16x32_bf16 v[80:83], v[220:223], v[188:191], v[80:83]
	s_waitcnt lgkmcnt(4)
	v_exp_f32 v155, v155
	v_mfma_f32_16x16x32_bf16 v[88:91], v[224:227], v[184:187], v[88:91]
	ds_read_b64_tr_b16 v[236:237], v13 offset:20480
	ds_read_b64_tr_b16 v[238:239], v13 offset:22528
	v_mfma_f32_16x16x32_bf16 v[96:99], v[224:227], v[188:191], v[96:99]
	v_exp_f32 v156, v156
	v_mfma_f32_16x16x32_bf16 v[176:179], v[252:255], v[184:187], v[176:179]
	ds_read_b64_tr_b16 v[240:241], v15 offset:20480
	ds_read_b64_tr_b16 v[242:243], v15 offset:22528
	v_mfma_f32_16x16x32_bf16 v[180:183], v[252:255], v[188:191], v[180:183]
	s_waitcnt lgkmcnt(6)
	s_barrier
	ds_read_b128 v[244:247], v22 offset:24576
	v_mfma_f32_16x16x32_bf16 v[44:47], v[228:231], v[184:187], v[44:47]
	ds_read_b128 v[248:251], v22 offset:26624
	v_cvt_pk_bf16_f32 v192, v152, v153
	v_mfma_f32_16x16x32_bf16 v[52:55], v[228:231], v[188:191], v[52:55]
	s_waitcnt lgkmcnt(6)
	v_exp_f32 v157, v157
	v_mfma_f32_16x16x32_bf16 v[60:63], v[232:235], v[184:187], v[60:63]
	ds_read_b128 v[200:203], v23 offset:24576
	v_cvt_pk_bf16_f32 v193, v154, v155
	v_mfma_f32_16x16x32_bf16 v[68:71], v[232:235], v[188:191], v[68:71]
	s_waitcnt lgkmcnt(5)
	v_exp_f32 v158, v158
	v_mfma_f32_16x16x32_bf16 v[76:79], v[236:239], v[184:187], v[76:79]
	ds_read_b128 v[204:207], v23 offset:26624
	v_cvt_pk_bf16_f32 v194, v156, v157
	v_mfma_f32_16x16x32_bf16 v[84:87], v[236:239], v[188:191], v[84:87]
	s_waitcnt lgkmcnt(4)
	v_exp_f32 v159, v159
	v_mfma_f32_16x16x32_bf16 v[92:95], v[240:243], v[184:187], v[92:95]
	ds_read_b128 v[208:211], v22 offset:28672
	v_cvt_pk_bf16_f32 v195, v158, v159
	v_mfma_f32_16x16x32_bf16 v[100:103], v[240:243], v[188:191], v[100:103]
	s_waitcnt lgkmcnt(4)
	v_exp_f32 v160, v160
	v_mfma_f32_16x16x32_bf16 v[136:139], v[244:247], v[104:107], v[168:171]
	ds_read_b128 v[212:215], v22 offset:30720
	v_mfma_f32_16x16x32_bf16 v[144:147], v[244:247], v[108:111], v[172:175]
	s_waitcnt lgkmcnt(4)
	v_exp_f32 v161, v161
	v_mfma_f32_16x16x32_bf16 v[140:143], v[248:251], v[104:107], v[168:171]
	ds_read_b128 v[216:219], v23 offset:28672
	v_cvt_pk_bf16_f32 v196, v160, v161
	v_mfma_f32_16x16x32_bf16 v[148:151], v[248:251], v[108:111], v[172:175]
	s_waitcnt lgkmcnt(4)
	v_exp_f32 v162, v162
	v_mfma_f32_16x16x32_bf16 v[136:139], v[200:203], v[112:115], v[136:139]
	ds_read_b128 v[220:223], v23 offset:30720
	v_mfma_f32_16x16x32_bf16 v[144:147], v[200:203], v[116:119], v[144:147]
	s_waitcnt lgkmcnt(4)
	v_exp_f32 v163, v163
	v_mfma_f32_16x16x32_bf16 v[140:143], v[204:207], v[112:115], v[140:143]
	ds_read_b64_tr_b16 v[224:225], v12 offset:32768
	ds_read_b64_tr_b16 v[226:227], v12 offset:34816
	v_mfma_f32_16x16x32_bf16 v[148:151], v[204:207], v[116:119], v[148:151]
	s_waitcnt lgkmcnt(5)
	v_exp_f32 v164, v164
	v_mfma_f32_16x16x32_bf16 v[136:139], v[208:211], v[120:123], v[136:139]
	ds_read_b64_tr_b16 v[228:229], v14 offset:32768
	ds_read_b64_tr_b16 v[230:231], v14 offset:34816
	v_mfma_f32_16x16x32_bf16 v[144:147], v[208:211], v[124:127], v[144:147]
	s_waitcnt lgkmcnt(6)
	v_exp_f32 v165, v165
	v_mfma_f32_16x16x32_bf16 v[140:143], v[212:215], v[120:123], v[140:143]
	ds_read_b64_tr_b16 v[232:233], v12 offset:36864
	ds_read_b64_tr_b16 v[234:235], v12 offset:38912
	v_mfma_f32_16x16x32_bf16 v[148:151], v[212:215], v[124:127], v[148:151]
	s_waitcnt lgkmcnt(7)
	v_exp_f32 v166, v166
	v_mfma_f32_16x16x32_bf16 v[136:139], v[216:219], v[128:131], v[136:139]
	ds_read_b64_tr_b16 v[236:237], v14 offset:36864
	ds_read_b64_tr_b16 v[238:239], v14 offset:38912
	v_mfma_f32_16x16x32_bf16 v[144:147], v[216:219], v[132:135], v[144:147]
	s_waitcnt lgkmcnt(8)
	v_exp_f32 v167, v167
	v_mfma_f32_16x16x32_bf16 v[140:143], v[220:223], v[128:131], v[140:143]
	v_cvt_pk_bf16_f32 v197, v162, v163
	v_cvt_pk_bf16_f32 v198, v164, v165
	v_mfma_f32_16x16x32_bf16 v[148:151], v[220:223], v[132:135], v[148:151]
	s_waitcnt lgkmcnt(6)
	v_cvt_pk_bf16_f32 v199, v166, v167
	v_mfma_f32_16x16x32_bf16 v[40:43], v[224:227], v[192:195], v[40:43]
	v_exp_f32 v136, v136
	v_mfma_f32_16x16x32_bf16 v[48:51], v[224:227], v[196:199], v[48:51]
	s_waitcnt lgkmcnt(4)
	v_exp_f32 v137, v137
	v_mfma_f32_16x16x32_bf16 v[56:59], v[228:231], v[192:195], v[56:59]
	ds_read_b64_tr_b16 v[240:241], v13 offset:32768
	ds_read_b64_tr_b16 v[242:243], v13 offset:34816
	v_mfma_f32_16x16x32_bf16 v[64:67], v[228:231], v[196:199], v[64:67]
	s_waitcnt lgkmcnt(4)
	v_exp_f32 v138, v138
	v_mfma_f32_16x16x32_bf16 v[72:75], v[232:235], v[192:195], v[72:75]
	ds_read_b64_tr_b16 v[244:245], v15 offset:32768
	ds_read_b64_tr_b16 v[246:247], v15 offset:34816
	v_mfma_f32_16x16x32_bf16 v[80:83], v[232:235], v[196:199], v[80:83]
	s_waitcnt lgkmcnt(4)
	v_exp_f32 v139, v139
	v_mfma_f32_16x16x32_bf16 v[88:91], v[236:239], v[192:195], v[88:91]
	ds_read_b64_tr_b16 v[248:249], v13 offset:36864
	ds_read_b64_tr_b16 v[250:251], v13 offset:38912
	v_mfma_f32_16x16x32_bf16 v[96:99], v[236:239], v[196:199], v[96:99]
	v_exp_f32 v140, v140
	v_mfma_f32_16x16x32_bf16 v[176:179], v[252:255], v[192:195], v[176:179]
	ds_read_b64_tr_b16 v[200:201], v15 offset:36864
	ds_read_b64_tr_b16 v[202:203], v15 offset:38912
	v_mfma_f32_16x16x32_bf16 v[180:183], v[252:255], v[196:199], v[180:183]
	s_waitcnt lgkmcnt(6)
	s_barrier
	ds_read_b128 v[204:207], v22 offset:40960
	v_mfma_f32_16x16x32_bf16 v[44:47], v[240:243], v[192:195], v[44:47]
	ds_read_b128 v[208:211], v22 offset:43008
	v_cvt_pk_bf16_f32 v184, v136, v137
	v_mfma_f32_16x16x32_bf16 v[52:55], v[240:243], v[196:199], v[52:55]
	s_waitcnt lgkmcnt(6)
	v_exp_f32 v141, v141
	v_mfma_f32_16x16x32_bf16 v[60:63], v[244:247], v[192:195], v[60:63]
	ds_read_b128 v[212:215], v23 offset:40960
	v_cvt_pk_bf16_f32 v185, v138, v139
	v_mfma_f32_16x16x32_bf16 v[68:71], v[244:247], v[196:199], v[68:71]
	s_waitcnt lgkmcnt(5)
	v_exp_f32 v142, v142
	v_mfma_f32_16x16x32_bf16 v[76:79], v[248:251], v[192:195], v[76:79]
	ds_read_b128 v[216:219], v23 offset:43008
	v_cvt_pk_bf16_f32 v186, v140, v141
	v_mfma_f32_16x16x32_bf16 v[84:87], v[248:251], v[196:199], v[84:87]
	s_waitcnt lgkmcnt(4)
	v_exp_f32 v143, v143
	v_mfma_f32_16x16x32_bf16 v[92:95], v[200:203], v[192:195], v[92:95]
	ds_read_b128 v[220:223], v22 offset:45056
	v_cvt_pk_bf16_f32 v187, v142, v143
	v_mfma_f32_16x16x32_bf16 v[100:103], v[200:203], v[196:199], v[100:103]
	s_waitcnt lgkmcnt(4)
	v_exp_f32 v144, v144
	v_mfma_f32_16x16x32_bf16 v[152:155], v[204:207], v[104:107], v[168:171]
	ds_read_b128 v[224:227], v22 offset:47104
	v_mfma_f32_16x16x32_bf16 v[160:163], v[204:207], v[108:111], v[172:175]
	s_waitcnt lgkmcnt(4)
	v_exp_f32 v145, v145
	v_mfma_f32_16x16x32_bf16 v[156:159], v[208:211], v[104:107], v[168:171]
	ds_read_b128 v[228:231], v23 offset:45056
	v_cvt_pk_bf16_f32 v188, v144, v145
	v_mfma_f32_16x16x32_bf16 v[164:167], v[208:211], v[108:111], v[172:175]
	s_waitcnt lgkmcnt(4)
	v_exp_f32 v146, v146
	v_mfma_f32_16x16x32_bf16 v[152:155], v[212:215], v[112:115], v[152:155]
	ds_read_b128 v[232:235], v23 offset:47104
	v_mfma_f32_16x16x32_bf16 v[160:163], v[212:215], v[116:119], v[160:163]
	s_waitcnt lgkmcnt(4)
	v_exp_f32 v147, v147
	v_mfma_f32_16x16x32_bf16 v[156:159], v[216:219], v[112:115], v[156:159]
	ds_read_b64_tr_b16 v[236:237], v12 offset:49152
	ds_read_b64_tr_b16 v[238:239], v12 offset:51200
	v_mfma_f32_16x16x32_bf16 v[164:167], v[216:219], v[116:119], v[164:167]
	s_waitcnt lgkmcnt(5)
	v_exp_f32 v148, v148
	v_mfma_f32_16x16x32_bf16 v[152:155], v[220:223], v[120:123], v[152:155]
	ds_read_b64_tr_b16 v[240:241], v14 offset:49152
	ds_read_b64_tr_b16 v[242:243], v14 offset:51200
	v_mfma_f32_16x16x32_bf16 v[160:163], v[220:223], v[124:127], v[160:163]
	s_waitcnt lgkmcnt(6)
	v_exp_f32 v149, v149
	v_mfma_f32_16x16x32_bf16 v[156:159], v[224:227], v[120:123], v[156:159]
	ds_read_b64_tr_b16 v[244:245], v12 offset:53248
	ds_read_b64_tr_b16 v[246:247], v12 offset:55296
	v_mfma_f32_16x16x32_bf16 v[164:167], v[224:227], v[124:127], v[164:167]
	s_waitcnt lgkmcnt(7)
	v_exp_f32 v150, v150
	v_mfma_f32_16x16x32_bf16 v[152:155], v[228:231], v[128:131], v[152:155]
	ds_read_b64_tr_b16 v[248:249], v14 offset:53248
	ds_read_b64_tr_b16 v[250:251], v14 offset:55296
	v_mfma_f32_16x16x32_bf16 v[160:163], v[228:231], v[132:135], v[160:163]
	s_waitcnt lgkmcnt(8)
	v_exp_f32 v151, v151
	v_mfma_f32_16x16x32_bf16 v[156:159], v[232:235], v[128:131], v[156:159]
	v_cvt_pk_bf16_f32 v189, v146, v147
	v_cvt_pk_bf16_f32 v190, v148, v149
	v_mfma_f32_16x16x32_bf16 v[164:167], v[232:235], v[132:135], v[164:167]
	s_waitcnt lgkmcnt(6)
	v_cvt_pk_bf16_f32 v191, v150, v151
	v_mfma_f32_16x16x32_bf16 v[40:43], v[236:239], v[184:187], v[40:43]
	v_exp_f32 v152, v152
	v_mfma_f32_16x16x32_bf16 v[48:51], v[236:239], v[188:191], v[48:51]
	s_waitcnt lgkmcnt(4)
	v_exp_f32 v153, v153
	v_mfma_f32_16x16x32_bf16 v[56:59], v[240:243], v[184:187], v[56:59]
	ds_read_b64_tr_b16 v[200:201], v13 offset:49152
	ds_read_b64_tr_b16 v[202:203], v13 offset:51200
	v_mfma_f32_16x16x32_bf16 v[64:67], v[240:243], v[188:191], v[64:67]
	s_waitcnt lgkmcnt(4)
	v_exp_f32 v154, v154
	v_mfma_f32_16x16x32_bf16 v[72:75], v[244:247], v[184:187], v[72:75]
	ds_read_b64_tr_b16 v[204:205], v15 offset:49152
	ds_read_b64_tr_b16 v[206:207], v15 offset:51200
	v_mfma_f32_16x16x32_bf16 v[80:83], v[244:247], v[188:191], v[80:83]
	s_waitcnt lgkmcnt(4)
	v_exp_f32 v155, v155
	v_mfma_f32_16x16x32_bf16 v[88:91], v[248:251], v[184:187], v[88:91]
	ds_read_b64_tr_b16 v[208:209], v13 offset:53248
	ds_read_b64_tr_b16 v[210:211], v13 offset:55296
	v_mfma_f32_16x16x32_bf16 v[96:99], v[248:251], v[188:191], v[96:99]
	v_exp_f32 v156, v156
	v_mfma_f32_16x16x32_bf16 v[176:179], v[252:255], v[184:187], v[176:179]
	ds_read_b64_tr_b16 v[212:213], v15 offset:53248
	ds_read_b64_tr_b16 v[214:215], v15 offset:55296
	v_mfma_f32_16x16x32_bf16 v[180:183], v[252:255], v[188:191], v[180:183]
	s_waitcnt lgkmcnt(6)
	s_barrier
	ds_read_b128 v[216:219], v22 offset:57344
	v_mfma_f32_16x16x32_bf16 v[44:47], v[200:203], v[184:187], v[44:47]
	ds_read_b128 v[220:223], v22 offset:59392
	v_cvt_pk_bf16_f32 v192, v152, v153
	v_mfma_f32_16x16x32_bf16 v[52:55], v[200:203], v[188:191], v[52:55]
	s_waitcnt lgkmcnt(6)
	v_exp_f32 v157, v157
	v_mfma_f32_16x16x32_bf16 v[60:63], v[204:207], v[184:187], v[60:63]
	ds_read_b128 v[224:227], v23 offset:57344
	v_cvt_pk_bf16_f32 v193, v154, v155
	v_mfma_f32_16x16x32_bf16 v[68:71], v[204:207], v[188:191], v[68:71]
	s_waitcnt lgkmcnt(5)
	v_exp_f32 v158, v158
	v_mfma_f32_16x16x32_bf16 v[76:79], v[208:211], v[184:187], v[76:79]
	ds_read_b128 v[228:231], v23 offset:59392
	v_cvt_pk_bf16_f32 v194, v156, v157
	v_mfma_f32_16x16x32_bf16 v[84:87], v[208:211], v[188:191], v[84:87]
	s_waitcnt lgkmcnt(4)
	v_exp_f32 v159, v159
	v_mfma_f32_16x16x32_bf16 v[92:95], v[212:215], v[184:187], v[92:95]
	ds_read_b128 v[232:235], v22 offset:61440
	v_cvt_pk_bf16_f32 v195, v158, v159
	v_mfma_f32_16x16x32_bf16 v[100:103], v[212:215], v[188:191], v[100:103]
	s_waitcnt lgkmcnt(4)
	v_exp_f32 v160, v160
	v_mfma_f32_16x16x32_bf16 v[136:139], v[216:219], v[104:107], v[168:171]
	ds_read_b128 v[236:239], v22 offset:63488
	v_mfma_f32_16x16x32_bf16 v[144:147], v[216:219], v[108:111], v[172:175]
	s_waitcnt lgkmcnt(4)
	v_exp_f32 v161, v161
	v_mfma_f32_16x16x32_bf16 v[140:143], v[220:223], v[104:107], v[168:171]
	ds_read_b128 v[240:243], v23 offset:61440
	v_cvt_pk_bf16_f32 v196, v160, v161
	v_mfma_f32_16x16x32_bf16 v[148:151], v[220:223], v[108:111], v[172:175]
	s_waitcnt lgkmcnt(4)
	v_exp_f32 v162, v162
	v_mfma_f32_16x16x32_bf16 v[136:139], v[224:227], v[112:115], v[136:139]
	ds_read_b128 v[244:247], v23 offset:63488
	v_mfma_f32_16x16x32_bf16 v[144:147], v[224:227], v[116:119], v[144:147]
	s_waitcnt lgkmcnt(4)
	v_exp_f32 v163, v163
	v_mfma_f32_16x16x32_bf16 v[140:143], v[228:231], v[112:115], v[140:143]
	ds_read_b64_tr_b16 v[248:249], v16 offset:0
	ds_read_b64_tr_b16 v[250:251], v16 offset:2048
	v_mfma_f32_16x16x32_bf16 v[148:151], v[228:231], v[116:119], v[148:151]
	s_waitcnt lgkmcnt(5)
	v_exp_f32 v164, v164
	v_mfma_f32_16x16x32_bf16 v[136:139], v[232:235], v[120:123], v[136:139]
	ds_read_b64_tr_b16 v[200:201], v18 offset:0
	ds_read_b64_tr_b16 v[202:203], v18 offset:2048
	v_mfma_f32_16x16x32_bf16 v[144:147], v[232:235], v[124:127], v[144:147]
	s_waitcnt lgkmcnt(6)
	v_exp_f32 v165, v165
	v_mfma_f32_16x16x32_bf16 v[140:143], v[236:239], v[120:123], v[140:143]
	ds_read_b64_tr_b16 v[204:205], v16 offset:4096
	ds_read_b64_tr_b16 v[206:207], v16 offset:6144
	v_mfma_f32_16x16x32_bf16 v[148:151], v[236:239], v[124:127], v[148:151]
	s_waitcnt lgkmcnt(7)
	v_exp_f32 v166, v166
	v_mfma_f32_16x16x32_bf16 v[136:139], v[240:243], v[128:131], v[136:139]
	ds_read_b64_tr_b16 v[208:209], v18 offset:4096
	ds_read_b64_tr_b16 v[210:211], v18 offset:6144
	v_mfma_f32_16x16x32_bf16 v[144:147], v[240:243], v[132:135], v[144:147]
	s_waitcnt lgkmcnt(8)
	v_exp_f32 v167, v167
	v_mfma_f32_16x16x32_bf16 v[140:143], v[244:247], v[128:131], v[140:143]
	v_cvt_pk_bf16_f32 v197, v162, v163
	v_cvt_pk_bf16_f32 v198, v164, v165
	v_mfma_f32_16x16x32_bf16 v[148:151], v[244:247], v[132:135], v[148:151]
	s_waitcnt lgkmcnt(6)
	v_cvt_pk_bf16_f32 v199, v166, v167
	v_mfma_f32_16x16x32_bf16 v[40:43], v[248:251], v[192:195], v[40:43]
	v_exp_f32 v136, v136
	v_mfma_f32_16x16x32_bf16 v[48:51], v[248:251], v[196:199], v[48:51]
	s_waitcnt lgkmcnt(4)
	v_exp_f32 v137, v137
	v_mfma_f32_16x16x32_bf16 v[56:59], v[200:203], v[192:195], v[56:59]
	ds_read_b64_tr_b16 v[212:213], v17 offset:0
	ds_read_b64_tr_b16 v[214:215], v17 offset:2048
	v_mfma_f32_16x16x32_bf16 v[64:67], v[200:203], v[196:199], v[64:67]
	s_waitcnt lgkmcnt(4)
	v_exp_f32 v138, v138
	v_mfma_f32_16x16x32_bf16 v[72:75], v[204:207], v[192:195], v[72:75]
	ds_read_b64_tr_b16 v[216:217], v19 offset:0
	ds_read_b64_tr_b16 v[218:219], v19 offset:2048
	v_mfma_f32_16x16x32_bf16 v[80:83], v[204:207], v[196:199], v[80:83]
	s_waitcnt lgkmcnt(4)
	v_exp_f32 v139, v139
	v_mfma_f32_16x16x32_bf16 v[88:91], v[208:211], v[192:195], v[88:91]
	ds_read_b64_tr_b16 v[220:221], v17 offset:4096
	ds_read_b64_tr_b16 v[222:223], v17 offset:6144
	v_mfma_f32_16x16x32_bf16 v[96:99], v[208:211], v[196:199], v[96:99]
	v_exp_f32 v140, v140
	v_mfma_f32_16x16x32_bf16 v[176:179], v[252:255], v[192:195], v[176:179]
	ds_read_b64_tr_b16 v[224:225], v19 offset:4096
	ds_read_b64_tr_b16 v[226:227], v19 offset:6144
	v_mfma_f32_16x16x32_bf16 v[180:183], v[252:255], v[196:199], v[180:183]
	s_waitcnt lgkmcnt(6)
	s_barrier
	ds_read_b128 v[228:231], v24 offset:8192
	v_mfma_f32_16x16x32_bf16 v[44:47], v[212:215], v[192:195], v[44:47]
	ds_read_b128 v[232:235], v24 offset:10240
	v_cvt_pk_bf16_f32 v184, v136, v137
	v_mfma_f32_16x16x32_bf16 v[52:55], v[212:215], v[196:199], v[52:55]
	s_waitcnt lgkmcnt(6)
	v_exp_f32 v141, v141
	v_mfma_f32_16x16x32_bf16 v[60:63], v[216:219], v[192:195], v[60:63]
	ds_read_b128 v[236:239], v25 offset:8192
	v_cvt_pk_bf16_f32 v185, v138, v139
	v_mfma_f32_16x16x32_bf16 v[68:71], v[216:219], v[196:199], v[68:71]
	s_waitcnt lgkmcnt(5)
	v_exp_f32 v142, v142
	v_mfma_f32_16x16x32_bf16 v[76:79], v[220:223], v[192:195], v[76:79]
	ds_read_b128 v[240:243], v25 offset:10240
	v_cvt_pk_bf16_f32 v186, v140, v141
	v_mfma_f32_16x16x32_bf16 v[84:87], v[220:223], v[196:199], v[84:87]
	s_waitcnt lgkmcnt(4)
	v_exp_f32 v143, v143
	v_mfma_f32_16x16x32_bf16 v[92:95], v[224:227], v[192:195], v[92:95]
	ds_read_b128 v[244:247], v24 offset:12288
	v_cvt_pk_bf16_f32 v187, v142, v143
	v_mfma_f32_16x16x32_bf16 v[100:103], v[224:227], v[196:199], v[100:103]
	s_waitcnt lgkmcnt(4)
	s_waitcnt vmcnt(0)
	v_exp_f32 v144, v144
	v_mfma_f32_16x16x32_bf16 v[152:155], v[228:231], v[104:107], v[168:171]
	ds_read_b128 v[248:251], v24 offset:14336
	v_mfma_f32_16x16x32_bf16 v[160:163], v[228:231], v[108:111], v[172:175]
	s_waitcnt lgkmcnt(4)
	v_exp_f32 v145, v145
	v_mfma_f32_16x16x32_bf16 v[156:159], v[232:235], v[104:107], v[168:171]
	ds_read_b128 v[200:203], v25 offset:12288
	v_cvt_pk_bf16_f32 v188, v144, v145
	v_mfma_f32_16x16x32_bf16 v[164:167], v[232:235], v[108:111], v[172:175]
	s_waitcnt lgkmcnt(4)
	v_exp_f32 v146, v146
	v_mfma_f32_16x16x32_bf16 v[152:155], v[236:239], v[112:115], v[152:155]
	ds_read_b128 v[204:207], v25 offset:14336
	v_mfma_f32_16x16x32_bf16 v[160:163], v[236:239], v[116:119], v[160:163]
	s_waitcnt lgkmcnt(4)
	v_exp_f32 v147, v147
	v_mfma_f32_16x16x32_bf16 v[156:159], v[240:243], v[112:115], v[156:159]
	ds_read_b64_tr_b16 v[208:209], v16 offset:16384
	ds_read_b64_tr_b16 v[210:211], v16 offset:18432
	v_mfma_f32_16x16x32_bf16 v[164:167], v[240:243], v[116:119], v[164:167]
	s_waitcnt lgkmcnt(5)
	v_exp_f32 v148, v148
	v_mfma_f32_16x16x32_bf16 v[152:155], v[244:247], v[120:123], v[152:155]
	ds_read_b64_tr_b16 v[212:213], v18 offset:16384
	ds_read_b64_tr_b16 v[214:215], v18 offset:18432
	v_mfma_f32_16x16x32_bf16 v[160:163], v[244:247], v[124:127], v[160:163]
	s_waitcnt lgkmcnt(6)
	v_exp_f32 v149, v149
	v_mfma_f32_16x16x32_bf16 v[156:159], v[248:251], v[120:123], v[156:159]
	ds_read_b64_tr_b16 v[216:217], v16 offset:20480
	ds_read_b64_tr_b16 v[218:219], v16 offset:22528
	v_mfma_f32_16x16x32_bf16 v[164:167], v[248:251], v[124:127], v[164:167]
	s_waitcnt lgkmcnt(7)
	v_exp_f32 v150, v150
	v_mfma_f32_16x16x32_bf16 v[152:155], v[200:203], v[128:131], v[152:155]
	ds_read_b64_tr_b16 v[220:221], v18 offset:20480
	ds_read_b64_tr_b16 v[222:223], v18 offset:22528
	v_mfma_f32_16x16x32_bf16 v[160:163], v[200:203], v[132:135], v[160:163]
	s_waitcnt lgkmcnt(8)
	v_exp_f32 v151, v151
	v_mfma_f32_16x16x32_bf16 v[156:159], v[204:207], v[128:131], v[156:159]
	v_cvt_pk_bf16_f32 v189, v146, v147
	v_cvt_pk_bf16_f32 v190, v148, v149
	v_mfma_f32_16x16x32_bf16 v[164:167], v[204:207], v[132:135], v[164:167]
	s_waitcnt lgkmcnt(6)
	v_cvt_pk_bf16_f32 v191, v150, v151
	v_mfma_f32_16x16x32_bf16 v[40:43], v[208:211], v[184:187], v[40:43]
	v_exp_f32 v152, v152
	v_mfma_f32_16x16x32_bf16 v[48:51], v[208:211], v[188:191], v[48:51]
	s_waitcnt lgkmcnt(4)
	v_exp_f32 v153, v153
	v_mfma_f32_16x16x32_bf16 v[56:59], v[212:215], v[184:187], v[56:59]
	ds_read_b64_tr_b16 v[224:225], v17 offset:16384
	ds_read_b64_tr_b16 v[226:227], v17 offset:18432
	v_mfma_f32_16x16x32_bf16 v[64:67], v[212:215], v[188:191], v[64:67]
	s_waitcnt lgkmcnt(4)
	v_exp_f32 v154, v154
	v_mfma_f32_16x16x32_bf16 v[72:75], v[216:219], v[184:187], v[72:75]
	ds_read_b64_tr_b16 v[228:229], v19 offset:16384
	ds_read_b64_tr_b16 v[230:231], v19 offset:18432
	v_mfma_f32_16x16x32_bf16 v[80:83], v[216:219], v[188:191], v[80:83]
	s_waitcnt lgkmcnt(4)
	v_exp_f32 v155, v155
	v_mfma_f32_16x16x32_bf16 v[88:91], v[220:223], v[184:187], v[88:91]
	ds_read_b64_tr_b16 v[232:233], v17 offset:20480
	ds_read_b64_tr_b16 v[234:235], v17 offset:22528
	v_mfma_f32_16x16x32_bf16 v[96:99], v[220:223], v[188:191], v[96:99]
	v_exp_f32 v156, v156
	v_mfma_f32_16x16x32_bf16 v[176:179], v[252:255], v[184:187], v[176:179]
	ds_read_b64_tr_b16 v[236:237], v19 offset:20480
	ds_read_b64_tr_b16 v[238:239], v19 offset:22528
	v_mfma_f32_16x16x32_bf16 v[180:183], v[252:255], v[188:191], v[180:183]
	s_waitcnt lgkmcnt(6)
	s_barrier
	ds_read_b128 v[240:243], v24 offset:24576
	v_mfma_f32_16x16x32_bf16 v[44:47], v[224:227], v[184:187], v[44:47]
	ds_read_b128 v[244:247], v24 offset:26624
	v_cvt_pk_bf16_f32 v192, v152, v153
	v_mfma_f32_16x16x32_bf16 v[52:55], v[224:227], v[188:191], v[52:55]
	s_waitcnt lgkmcnt(6)
	v_exp_f32 v157, v157
	v_mfma_f32_16x16x32_bf16 v[60:63], v[228:231], v[184:187], v[60:63]
	ds_read_b128 v[248:251], v25 offset:24576
	v_cvt_pk_bf16_f32 v193, v154, v155
	v_mfma_f32_16x16x32_bf16 v[68:71], v[228:231], v[188:191], v[68:71]
	s_waitcnt lgkmcnt(5)
	v_exp_f32 v158, v158
	v_mfma_f32_16x16x32_bf16 v[76:79], v[232:235], v[184:187], v[76:79]
	ds_read_b128 v[200:203], v25 offset:26624
	v_cvt_pk_bf16_f32 v194, v156, v157
	v_mfma_f32_16x16x32_bf16 v[84:87], v[232:235], v[188:191], v[84:87]
	s_waitcnt lgkmcnt(4)
	v_exp_f32 v159, v159
	v_mfma_f32_16x16x32_bf16 v[92:95], v[236:239], v[184:187], v[92:95]
	ds_read_b128 v[204:207], v24 offset:28672
	v_cvt_pk_bf16_f32 v195, v158, v159
	v_mfma_f32_16x16x32_bf16 v[100:103], v[236:239], v[188:191], v[100:103]
	s_waitcnt lgkmcnt(4)
	v_exp_f32 v160, v160
	v_mfma_f32_16x16x32_bf16 v[136:139], v[240:243], v[104:107], v[168:171]
	ds_read_b128 v[208:211], v24 offset:30720
	v_mfma_f32_16x16x32_bf16 v[144:147], v[240:243], v[108:111], v[172:175]
	s_waitcnt lgkmcnt(4)
	v_exp_f32 v161, v161
	v_mfma_f32_16x16x32_bf16 v[140:143], v[244:247], v[104:107], v[168:171]
	ds_read_b128 v[212:215], v25 offset:28672
	v_cvt_pk_bf16_f32 v196, v160, v161
	v_mfma_f32_16x16x32_bf16 v[148:151], v[244:247], v[108:111], v[172:175]
	s_waitcnt lgkmcnt(4)
	v_exp_f32 v162, v162
	v_mfma_f32_16x16x32_bf16 v[136:139], v[248:251], v[112:115], v[136:139]
	ds_read_b128 v[216:219], v25 offset:30720
	v_mfma_f32_16x16x32_bf16 v[144:147], v[248:251], v[116:119], v[144:147]
	s_waitcnt lgkmcnt(4)
	v_exp_f32 v163, v163
	v_mfma_f32_16x16x32_bf16 v[140:143], v[200:203], v[112:115], v[140:143]
	ds_read_b64_tr_b16 v[220:221], v8 offset:0
	ds_read_b64_tr_b16 v[222:223], v8 offset:2048
	v_mfma_f32_16x16x32_bf16 v[148:151], v[200:203], v[116:119], v[148:151]
	s_waitcnt lgkmcnt(5)
	v_exp_f32 v164, v164
	v_mfma_f32_16x16x32_bf16 v[136:139], v[204:207], v[120:123], v[136:139]
	ds_read_b64_tr_b16 v[224:225], v10 offset:0
	ds_read_b64_tr_b16 v[226:227], v10 offset:2048
	v_mfma_f32_16x16x32_bf16 v[144:147], v[204:207], v[124:127], v[144:147]
	s_waitcnt lgkmcnt(6)
	v_exp_f32 v165, v165
	v_mfma_f32_16x16x32_bf16 v[140:143], v[208:211], v[120:123], v[140:143]
	ds_read_b64_tr_b16 v[228:229], v8 offset:4096
	ds_read_b64_tr_b16 v[230:231], v8 offset:6144
	v_mfma_f32_16x16x32_bf16 v[148:151], v[208:211], v[124:127], v[148:151]
	s_waitcnt lgkmcnt(7)
	v_exp_f32 v166, v166
	v_mfma_f32_16x16x32_bf16 v[136:139], v[212:215], v[128:131], v[136:139]
	ds_read_b64_tr_b16 v[232:233], v10 offset:4096
	ds_read_b64_tr_b16 v[234:235], v10 offset:6144
	v_mfma_f32_16x16x32_bf16 v[144:147], v[212:215], v[132:135], v[144:147]
	s_waitcnt lgkmcnt(8)
	v_exp_f32 v167, v167
	v_mfma_f32_16x16x32_bf16 v[140:143], v[216:219], v[128:131], v[140:143]
	v_cvt_pk_bf16_f32 v197, v162, v163
	v_cvt_pk_bf16_f32 v198, v164, v165
	v_mfma_f32_16x16x32_bf16 v[148:151], v[216:219], v[132:135], v[148:151]
	s_waitcnt lgkmcnt(6)
	v_cvt_pk_bf16_f32 v199, v166, v167
	v_mfma_f32_16x16x32_bf16 v[40:43], v[220:223], v[192:195], v[40:43]
	v_exp_f32 v136, v136
	v_mfma_f32_16x16x32_bf16 v[48:51], v[220:223], v[196:199], v[48:51]
	s_waitcnt lgkmcnt(4)
	v_exp_f32 v137, v137
	v_mfma_f32_16x16x32_bf16 v[56:59], v[224:227], v[192:195], v[56:59]
	ds_read_b64_tr_b16 v[236:237], v9 offset:0
	ds_read_b64_tr_b16 v[238:239], v9 offset:2048
	v_mfma_f32_16x16x32_bf16 v[64:67], v[224:227], v[196:199], v[64:67]
	s_waitcnt lgkmcnt(4)
	v_exp_f32 v138, v138
	v_mfma_f32_16x16x32_bf16 v[72:75], v[228:231], v[192:195], v[72:75]
	ds_read_b64_tr_b16 v[240:241], v11 offset:0
	ds_read_b64_tr_b16 v[242:243], v11 offset:2048
	v_mfma_f32_16x16x32_bf16 v[80:83], v[228:231], v[196:199], v[80:83]
	s_waitcnt lgkmcnt(4)
	v_exp_f32 v139, v139
	v_mfma_f32_16x16x32_bf16 v[88:91], v[232:235], v[192:195], v[88:91]
	ds_read_b64_tr_b16 v[244:245], v9 offset:4096
	ds_read_b64_tr_b16 v[246:247], v9 offset:6144
	v_mfma_f32_16x16x32_bf16 v[96:99], v[232:235], v[196:199], v[96:99]
	v_exp_f32 v140, v140
	v_mfma_f32_16x16x32_bf16 v[176:179], v[252:255], v[192:195], v[176:179]
	ds_read_b64_tr_b16 v[248:249], v11 offset:4096
	ds_read_b64_tr_b16 v[250:251], v11 offset:6144
	v_mfma_f32_16x16x32_bf16 v[180:183], v[252:255], v[196:199], v[180:183]
	s_waitcnt lgkmcnt(6)
	s_barrier
	ds_read_b128 v[200:203], v20 offset:8192
	v_mfma_f32_16x16x32_bf16 v[44:47], v[236:239], v[192:195], v[44:47]
	ds_read_b128 v[204:207], v20 offset:10240
	v_cvt_pk_bf16_f32 v184, v136, v137
	v_mfma_f32_16x16x32_bf16 v[52:55], v[236:239], v[196:199], v[52:55]
	s_waitcnt lgkmcnt(6)
	v_exp_f32 v141, v141
	v_mfma_f32_16x16x32_bf16 v[60:63], v[240:243], v[192:195], v[60:63]
	ds_read_b128 v[208:211], v21 offset:8192
	v_cvt_pk_bf16_f32 v185, v138, v139
	v_mfma_f32_16x16x32_bf16 v[68:71], v[240:243], v[196:199], v[68:71]
	s_waitcnt lgkmcnt(5)
	v_exp_f32 v142, v142
	v_mfma_f32_16x16x32_bf16 v[76:79], v[244:247], v[192:195], v[76:79]
	ds_read_b128 v[212:215], v21 offset:10240
	v_cvt_pk_bf16_f32 v186, v140, v141
	v_mfma_f32_16x16x32_bf16 v[84:87], v[244:247], v[196:199], v[84:87]
	s_waitcnt lgkmcnt(4)
	v_exp_f32 v143, v143
	v_mfma_f32_16x16x32_bf16 v[92:95], v[248:251], v[192:195], v[92:95]
	ds_read_b128 v[216:219], v20 offset:12288
	v_cvt_pk_bf16_f32 v187, v142, v143
	v_mfma_f32_16x16x32_bf16 v[100:103], v[248:251], v[196:199], v[100:103]
	s_waitcnt lgkmcnt(4)
	v_exp_f32 v144, v144
	v_mfma_f32_16x16x32_bf16 v[152:155], v[200:203], v[104:107], v[168:171]
	ds_read_b128 v[220:223], v20 offset:14336
	v_mfma_f32_16x16x32_bf16 v[160:163], v[200:203], v[108:111], v[172:175]
	s_waitcnt lgkmcnt(4)
	v_exp_f32 v145, v145
	v_mfma_f32_16x16x32_bf16 v[156:159], v[204:207], v[104:107], v[168:171]
	ds_read_b128 v[224:227], v21 offset:12288
	v_cvt_pk_bf16_f32 v188, v144, v145
	v_mfma_f32_16x16x32_bf16 v[164:167], v[204:207], v[108:111], v[172:175]
	s_waitcnt lgkmcnt(4)
	v_exp_f32 v146, v146
	v_mfma_f32_16x16x32_bf16 v[152:155], v[208:211], v[112:115], v[152:155]
	ds_read_b128 v[228:231], v21 offset:14336
	v_mfma_f32_16x16x32_bf16 v[160:163], v[208:211], v[116:119], v[160:163]
	s_waitcnt lgkmcnt(4)
	v_exp_f32 v147, v147
	v_mfma_f32_16x16x32_bf16 v[156:159], v[212:215], v[112:115], v[156:159]
	ds_read_b64_tr_b16 v[232:233], v8 offset:16384
	ds_read_b64_tr_b16 v[234:235], v8 offset:18432
	v_mfma_f32_16x16x32_bf16 v[164:167], v[212:215], v[116:119], v[164:167]
	s_waitcnt lgkmcnt(5)
	v_exp_f32 v148, v148
	v_mfma_f32_16x16x32_bf16 v[152:155], v[216:219], v[120:123], v[152:155]
	ds_read_b64_tr_b16 v[236:237], v10 offset:16384
	ds_read_b64_tr_b16 v[238:239], v10 offset:18432
	v_mfma_f32_16x16x32_bf16 v[160:163], v[216:219], v[124:127], v[160:163]
	s_waitcnt lgkmcnt(6)
	v_exp_f32 v149, v149
	v_mfma_f32_16x16x32_bf16 v[156:159], v[220:223], v[120:123], v[156:159]
	ds_read_b64_tr_b16 v[240:241], v8 offset:20480
	ds_read_b64_tr_b16 v[242:243], v8 offset:22528
	v_mfma_f32_16x16x32_bf16 v[164:167], v[220:223], v[124:127], v[164:167]
	s_waitcnt lgkmcnt(7)
	v_exp_f32 v150, v150
	v_mfma_f32_16x16x32_bf16 v[152:155], v[224:227], v[128:131], v[152:155]
	ds_read_b64_tr_b16 v[244:245], v10 offset:20480
	ds_read_b64_tr_b16 v[246:247], v10 offset:22528
	v_mfma_f32_16x16x32_bf16 v[160:163], v[224:227], v[132:135], v[160:163]
	s_waitcnt lgkmcnt(8)
	v_exp_f32 v151, v151
	v_mfma_f32_16x16x32_bf16 v[156:159], v[228:231], v[128:131], v[156:159]
	v_cvt_pk_bf16_f32 v189, v146, v147
	v_cvt_pk_bf16_f32 v190, v148, v149
	v_mfma_f32_16x16x32_bf16 v[164:167], v[228:231], v[132:135], v[164:167]
	s_waitcnt lgkmcnt(6)
	v_cvt_pk_bf16_f32 v191, v150, v151
	v_mfma_f32_16x16x32_bf16 v[40:43], v[232:235], v[184:187], v[40:43]
	v_exp_f32 v152, v152
	v_mfma_f32_16x16x32_bf16 v[48:51], v[232:235], v[188:191], v[48:51]
	s_waitcnt lgkmcnt(4)
	v_exp_f32 v153, v153
	v_mfma_f32_16x16x32_bf16 v[56:59], v[236:239], v[184:187], v[56:59]
	ds_read_b64_tr_b16 v[248:249], v9 offset:16384
	ds_read_b64_tr_b16 v[250:251], v9 offset:18432
	v_mfma_f32_16x16x32_bf16 v[64:67], v[236:239], v[188:191], v[64:67]
	s_waitcnt lgkmcnt(4)
	v_exp_f32 v154, v154
	v_mfma_f32_16x16x32_bf16 v[72:75], v[240:243], v[184:187], v[72:75]
	ds_read_b64_tr_b16 v[200:201], v11 offset:16384
	ds_read_b64_tr_b16 v[202:203], v11 offset:18432
	v_mfma_f32_16x16x32_bf16 v[80:83], v[240:243], v[188:191], v[80:83]
	s_waitcnt lgkmcnt(4)
	v_exp_f32 v155, v155
	v_mfma_f32_16x16x32_bf16 v[88:91], v[244:247], v[184:187], v[88:91]
	ds_read_b64_tr_b16 v[204:205], v9 offset:20480
	ds_read_b64_tr_b16 v[206:207], v9 offset:22528
	v_mfma_f32_16x16x32_bf16 v[96:99], v[244:247], v[188:191], v[96:99]
	v_exp_f32 v156, v156
	v_mfma_f32_16x16x32_bf16 v[176:179], v[252:255], v[184:187], v[176:179]
	ds_read_b64_tr_b16 v[208:209], v11 offset:20480
	ds_read_b64_tr_b16 v[210:211], v11 offset:22528
	v_mfma_f32_16x16x32_bf16 v[180:183], v[252:255], v[188:191], v[180:183]
	s_waitcnt lgkmcnt(6)
	s_barrier
	ds_read_b128 v[212:215], v20 offset:24576
	v_mfma_f32_16x16x32_bf16 v[44:47], v[248:251], v[184:187], v[44:47]
	ds_read_b128 v[216:219], v20 offset:26624
	v_cvt_pk_bf16_f32 v192, v152, v153
	v_mfma_f32_16x16x32_bf16 v[52:55], v[248:251], v[188:191], v[52:55]
	s_waitcnt lgkmcnt(6)
	v_exp_f32 v157, v157
	v_mfma_f32_16x16x32_bf16 v[60:63], v[200:203], v[184:187], v[60:63]
	ds_read_b128 v[220:223], v21 offset:24576
	v_cvt_pk_bf16_f32 v193, v154, v155
	v_mfma_f32_16x16x32_bf16 v[68:71], v[200:203], v[188:191], v[68:71]
	s_waitcnt lgkmcnt(5)
	v_exp_f32 v158, v158
	v_mfma_f32_16x16x32_bf16 v[76:79], v[204:207], v[184:187], v[76:79]
	ds_read_b128 v[224:227], v21 offset:26624
	v_cvt_pk_bf16_f32 v194, v156, v157
	v_mfma_f32_16x16x32_bf16 v[84:87], v[204:207], v[188:191], v[84:87]
	s_waitcnt lgkmcnt(4)
	v_exp_f32 v159, v159
	v_mfma_f32_16x16x32_bf16 v[92:95], v[208:211], v[184:187], v[92:95]
	ds_read_b128 v[228:231], v20 offset:28672
	v_cvt_pk_bf16_f32 v195, v158, v159
	v_mfma_f32_16x16x32_bf16 v[100:103], v[208:211], v[188:191], v[100:103]
	s_waitcnt lgkmcnt(4)
	v_exp_f32 v160, v160
	v_mfma_f32_16x16x32_bf16 v[136:139], v[212:215], v[104:107], v[168:171]
	ds_read_b128 v[232:235], v20 offset:30720
	v_mfma_f32_16x16x32_bf16 v[144:147], v[212:215], v[108:111], v[172:175]
	s_waitcnt lgkmcnt(4)
	v_exp_f32 v161, v161
	v_mfma_f32_16x16x32_bf16 v[140:143], v[216:219], v[104:107], v[168:171]
	ds_read_b128 v[236:239], v21 offset:28672
	v_cvt_pk_bf16_f32 v196, v160, v161
	v_mfma_f32_16x16x32_bf16 v[148:151], v[216:219], v[108:111], v[172:175]
	s_waitcnt lgkmcnt(4)
	v_exp_f32 v162, v162
	v_mfma_f32_16x16x32_bf16 v[136:139], v[220:223], v[112:115], v[136:139]
	ds_read_b128 v[240:243], v21 offset:30720
	v_mfma_f32_16x16x32_bf16 v[144:147], v[220:223], v[116:119], v[144:147]
	s_waitcnt lgkmcnt(4)
	v_exp_f32 v163, v163
	v_mfma_f32_16x16x32_bf16 v[140:143], v[224:227], v[112:115], v[140:143]
	ds_read_b64_tr_b16 v[244:245], v8 offset:32768
	ds_read_b64_tr_b16 v[246:247], v8 offset:34816
	v_mfma_f32_16x16x32_bf16 v[148:151], v[224:227], v[116:119], v[148:151]
	s_waitcnt lgkmcnt(5)
	v_exp_f32 v164, v164
	v_mfma_f32_16x16x32_bf16 v[136:139], v[228:231], v[120:123], v[136:139]
	ds_read_b64_tr_b16 v[248:249], v10 offset:32768
	ds_read_b64_tr_b16 v[250:251], v10 offset:34816
	v_mfma_f32_16x16x32_bf16 v[144:147], v[228:231], v[124:127], v[144:147]
	s_waitcnt lgkmcnt(6)
	v_exp_f32 v165, v165
	v_mfma_f32_16x16x32_bf16 v[140:143], v[232:235], v[120:123], v[140:143]
	ds_read_b64_tr_b16 v[200:201], v8 offset:36864
	ds_read_b64_tr_b16 v[202:203], v8 offset:38912
	v_mfma_f32_16x16x32_bf16 v[148:151], v[232:235], v[124:127], v[148:151]
	s_waitcnt lgkmcnt(7)
	v_exp_f32 v166, v166
	v_mfma_f32_16x16x32_bf16 v[136:139], v[236:239], v[128:131], v[136:139]
	ds_read_b64_tr_b16 v[204:205], v10 offset:36864
	ds_read_b64_tr_b16 v[206:207], v10 offset:38912
	v_mfma_f32_16x16x32_bf16 v[144:147], v[236:239], v[132:135], v[144:147]
	s_waitcnt lgkmcnt(8)
	v_exp_f32 v167, v167
	v_mfma_f32_16x16x32_bf16 v[140:143], v[240:243], v[128:131], v[140:143]
	v_cvt_pk_bf16_f32 v197, v162, v163
	v_cvt_pk_bf16_f32 v198, v164, v165
	v_mfma_f32_16x16x32_bf16 v[148:151], v[240:243], v[132:135], v[148:151]
	s_waitcnt lgkmcnt(6)
	v_cvt_pk_bf16_f32 v199, v166, v167
	v_mfma_f32_16x16x32_bf16 v[40:43], v[244:247], v[192:195], v[40:43]
	v_exp_f32 v136, v136
	v_mfma_f32_16x16x32_bf16 v[48:51], v[244:247], v[196:199], v[48:51]
	s_waitcnt lgkmcnt(4)
	v_exp_f32 v137, v137
	v_mfma_f32_16x16x32_bf16 v[56:59], v[248:251], v[192:195], v[56:59]
	ds_read_b64_tr_b16 v[208:209], v9 offset:32768
	ds_read_b64_tr_b16 v[210:211], v9 offset:34816
	v_mfma_f32_16x16x32_bf16 v[64:67], v[248:251], v[196:199], v[64:67]
	s_waitcnt lgkmcnt(4)
	v_exp_f32 v138, v138
	v_mfma_f32_16x16x32_bf16 v[72:75], v[200:203], v[192:195], v[72:75]
	ds_read_b64_tr_b16 v[212:213], v11 offset:32768
	ds_read_b64_tr_b16 v[214:215], v11 offset:34816
	v_mfma_f32_16x16x32_bf16 v[80:83], v[200:203], v[196:199], v[80:83]
	s_waitcnt lgkmcnt(4)
	v_exp_f32 v139, v139
	v_mfma_f32_16x16x32_bf16 v[88:91], v[204:207], v[192:195], v[88:91]
	ds_read_b64_tr_b16 v[216:217], v9 offset:36864
	ds_read_b64_tr_b16 v[218:219], v9 offset:38912
	v_mfma_f32_16x16x32_bf16 v[96:99], v[204:207], v[196:199], v[96:99]
	v_exp_f32 v140, v140
	v_mfma_f32_16x16x32_bf16 v[176:179], v[252:255], v[192:195], v[176:179]
	ds_read_b64_tr_b16 v[220:221], v11 offset:36864
	ds_read_b64_tr_b16 v[222:223], v11 offset:38912
	v_mfma_f32_16x16x32_bf16 v[180:183], v[252:255], v[196:199], v[180:183]
	s_waitcnt lgkmcnt(6)
	s_barrier
	ds_read_b128 v[224:227], v20 offset:40960
	v_mfma_f32_16x16x32_bf16 v[44:47], v[208:211], v[192:195], v[44:47]
	ds_read_b128 v[228:231], v20 offset:43008
	v_cvt_pk_bf16_f32 v184, v136, v137
	v_mfma_f32_16x16x32_bf16 v[52:55], v[208:211], v[196:199], v[52:55]
	s_waitcnt lgkmcnt(6)
	v_exp_f32 v141, v141
	v_mfma_f32_16x16x32_bf16 v[60:63], v[212:215], v[192:195], v[60:63]
	ds_read_b128 v[232:235], v21 offset:40960
	v_cvt_pk_bf16_f32 v185, v138, v139
	v_mfma_f32_16x16x32_bf16 v[68:71], v[212:215], v[196:199], v[68:71]
	s_waitcnt lgkmcnt(5)
	v_exp_f32 v142, v142
	v_mfma_f32_16x16x32_bf16 v[76:79], v[216:219], v[192:195], v[76:79]
	ds_read_b128 v[236:239], v21 offset:43008
	v_cvt_pk_bf16_f32 v186, v140, v141
	v_mfma_f32_16x16x32_bf16 v[84:87], v[216:219], v[196:199], v[84:87]
	s_waitcnt lgkmcnt(4)
	v_exp_f32 v143, v143
	v_mfma_f32_16x16x32_bf16 v[92:95], v[220:223], v[192:195], v[92:95]
	ds_read_b128 v[240:243], v20 offset:45056
	v_cvt_pk_bf16_f32 v187, v142, v143
	v_mfma_f32_16x16x32_bf16 v[100:103], v[220:223], v[196:199], v[100:103]
	s_waitcnt lgkmcnt(4)
	v_exp_f32 v144, v144
	v_mfma_f32_16x16x32_bf16 v[152:155], v[224:227], v[104:107], v[168:171]
	ds_read_b128 v[244:247], v20 offset:47104
	v_mfma_f32_16x16x32_bf16 v[160:163], v[224:227], v[108:111], v[172:175]
	s_waitcnt lgkmcnt(4)
	v_exp_f32 v145, v145
	v_mfma_f32_16x16x32_bf16 v[156:159], v[228:231], v[104:107], v[168:171]
	ds_read_b128 v[248:251], v21 offset:45056
	v_cvt_pk_bf16_f32 v188, v144, v145
	v_mfma_f32_16x16x32_bf16 v[164:167], v[228:231], v[108:111], v[172:175]
	s_waitcnt lgkmcnt(4)
	v_exp_f32 v146, v146
	v_mfma_f32_16x16x32_bf16 v[152:155], v[232:235], v[112:115], v[152:155]
	ds_read_b128 v[200:203], v21 offset:47104
	v_mfma_f32_16x16x32_bf16 v[160:163], v[232:235], v[116:119], v[160:163]
	s_waitcnt lgkmcnt(4)
	v_exp_f32 v147, v147
	v_mfma_f32_16x16x32_bf16 v[156:159], v[236:239], v[112:115], v[156:159]
	ds_read_b64_tr_b16 v[204:205], v8 offset:49152
	ds_read_b64_tr_b16 v[206:207], v8 offset:51200
	v_mfma_f32_16x16x32_bf16 v[164:167], v[236:239], v[116:119], v[164:167]
	s_waitcnt lgkmcnt(5)
	v_exp_f32 v148, v148
	v_mfma_f32_16x16x32_bf16 v[152:155], v[240:243], v[120:123], v[152:155]
	ds_read_b64_tr_b16 v[208:209], v10 offset:49152
	ds_read_b64_tr_b16 v[210:211], v10 offset:51200
	v_mfma_f32_16x16x32_bf16 v[160:163], v[240:243], v[124:127], v[160:163]
	s_waitcnt lgkmcnt(6)
	v_exp_f32 v149, v149
	v_mfma_f32_16x16x32_bf16 v[156:159], v[244:247], v[120:123], v[156:159]
	ds_read_b64_tr_b16 v[212:213], v8 offset:53248
	ds_read_b64_tr_b16 v[214:215], v8 offset:55296
	v_mfma_f32_16x16x32_bf16 v[164:167], v[244:247], v[124:127], v[164:167]
	s_waitcnt lgkmcnt(7)
	v_exp_f32 v150, v150
	v_mfma_f32_16x16x32_bf16 v[152:155], v[248:251], v[128:131], v[152:155]
	ds_read_b64_tr_b16 v[216:217], v10 offset:53248
	ds_read_b64_tr_b16 v[218:219], v10 offset:55296
	v_mfma_f32_16x16x32_bf16 v[160:163], v[248:251], v[132:135], v[160:163]
	s_waitcnt lgkmcnt(8)
	v_exp_f32 v151, v151
	v_mfma_f32_16x16x32_bf16 v[156:159], v[200:203], v[128:131], v[156:159]
	v_cvt_pk_bf16_f32 v189, v146, v147
	v_cvt_pk_bf16_f32 v190, v148, v149
	v_mfma_f32_16x16x32_bf16 v[164:167], v[200:203], v[132:135], v[164:167]
	s_waitcnt lgkmcnt(6)
	v_cvt_pk_bf16_f32 v191, v150, v151
	v_mfma_f32_16x16x32_bf16 v[40:43], v[204:207], v[184:187], v[40:43]
	v_exp_f32 v152, v152
	v_mfma_f32_16x16x32_bf16 v[48:51], v[204:207], v[188:191], v[48:51]
	s_waitcnt lgkmcnt(4)
	v_exp_f32 v153, v153
	v_mfma_f32_16x16x32_bf16 v[56:59], v[208:211], v[184:187], v[56:59]
	ds_read_b64_tr_b16 v[220:221], v9 offset:49152
	ds_read_b64_tr_b16 v[222:223], v9 offset:51200
	v_mfma_f32_16x16x32_bf16 v[64:67], v[208:211], v[188:191], v[64:67]
	s_waitcnt lgkmcnt(4)
	v_exp_f32 v154, v154
	v_mfma_f32_16x16x32_bf16 v[72:75], v[212:215], v[184:187], v[72:75]
	ds_read_b64_tr_b16 v[224:225], v11 offset:49152
	ds_read_b64_tr_b16 v[226:227], v11 offset:51200
	v_mfma_f32_16x16x32_bf16 v[80:83], v[212:215], v[188:191], v[80:83]
	s_waitcnt lgkmcnt(4)
	v_exp_f32 v155, v155
	v_mfma_f32_16x16x32_bf16 v[88:91], v[216:219], v[184:187], v[88:91]
	ds_read_b64_tr_b16 v[228:229], v9 offset:53248
	ds_read_b64_tr_b16 v[230:231], v9 offset:55296
	v_mfma_f32_16x16x32_bf16 v[96:99], v[216:219], v[188:191], v[96:99]
	v_exp_f32 v156, v156
	v_mfma_f32_16x16x32_bf16 v[176:179], v[252:255], v[184:187], v[176:179]
	ds_read_b64_tr_b16 v[232:233], v11 offset:53248
	ds_read_b64_tr_b16 v[234:235], v11 offset:55296
	v_mfma_f32_16x16x32_bf16 v[180:183], v[252:255], v[188:191], v[180:183]
	s_waitcnt lgkmcnt(6)
	s_barrier
	ds_read_b128 v[236:239], v20 offset:57344
	v_mfma_f32_16x16x32_bf16 v[44:47], v[220:223], v[184:187], v[44:47]
	ds_read_b128 v[240:243], v20 offset:59392
	v_cvt_pk_bf16_f32 v192, v152, v153
	v_mfma_f32_16x16x32_bf16 v[52:55], v[220:223], v[188:191], v[52:55]
	s_waitcnt lgkmcnt(6)
	v_exp_f32 v157, v157
	v_mfma_f32_16x16x32_bf16 v[60:63], v[224:227], v[184:187], v[60:63]
	ds_read_b128 v[244:247], v21 offset:57344
	v_cvt_pk_bf16_f32 v193, v154, v155
	v_mfma_f32_16x16x32_bf16 v[68:71], v[224:227], v[188:191], v[68:71]
	s_waitcnt lgkmcnt(5)
	v_exp_f32 v158, v158
	v_mfma_f32_16x16x32_bf16 v[76:79], v[228:231], v[184:187], v[76:79]
	ds_read_b128 v[248:251], v21 offset:59392
	v_cvt_pk_bf16_f32 v194, v156, v157
	v_mfma_f32_16x16x32_bf16 v[84:87], v[228:231], v[188:191], v[84:87]
	s_waitcnt lgkmcnt(4)
	v_exp_f32 v159, v159
	v_mfma_f32_16x16x32_bf16 v[92:95], v[232:235], v[184:187], v[92:95]
	ds_read_b128 v[200:203], v20 offset:61440
	v_cvt_pk_bf16_f32 v195, v158, v159
	v_mfma_f32_16x16x32_bf16 v[100:103], v[232:235], v[188:191], v[100:103]
	s_waitcnt lgkmcnt(4)
	v_exp_f32 v160, v160
	v_mfma_f32_16x16x32_bf16 v[136:139], v[236:239], v[104:107], v[168:171]
	ds_read_b128 v[204:207], v20 offset:63488
	v_mfma_f32_16x16x32_bf16 v[144:147], v[236:239], v[108:111], v[172:175]
	s_waitcnt lgkmcnt(4)
	v_exp_f32 v161, v161
	v_mfma_f32_16x16x32_bf16 v[140:143], v[240:243], v[104:107], v[168:171]
	ds_read_b128 v[208:211], v21 offset:61440
	v_cvt_pk_bf16_f32 v196, v160, v161
	v_mfma_f32_16x16x32_bf16 v[148:151], v[240:243], v[108:111], v[172:175]
	s_waitcnt lgkmcnt(4)
	v_exp_f32 v162, v162
	v_mfma_f32_16x16x32_bf16 v[136:139], v[244:247], v[112:115], v[136:139]
	ds_read_b128 v[212:215], v21 offset:63488
	v_mfma_f32_16x16x32_bf16 v[144:147], v[244:247], v[116:119], v[144:147]
	s_waitcnt lgkmcnt(4)
	v_exp_f32 v163, v163
	v_mfma_f32_16x16x32_bf16 v[140:143], v[248:251], v[112:115], v[140:143]
	ds_read_b64_tr_b16 v[216:217], v12 offset:0
	ds_read_b64_tr_b16 v[218:219], v12 offset:2048
	v_mfma_f32_16x16x32_bf16 v[148:151], v[248:251], v[116:119], v[148:151]
	s_waitcnt lgkmcnt(5)
	v_exp_f32 v164, v164
	v_mfma_f32_16x16x32_bf16 v[136:139], v[200:203], v[120:123], v[136:139]
	ds_read_b64_tr_b16 v[220:221], v14 offset:0
	ds_read_b64_tr_b16 v[222:223], v14 offset:2048
	v_mfma_f32_16x16x32_bf16 v[144:147], v[200:203], v[124:127], v[144:147]
	s_waitcnt lgkmcnt(6)
	v_exp_f32 v165, v165
	v_mfma_f32_16x16x32_bf16 v[140:143], v[204:207], v[120:123], v[140:143]
	ds_read_b64_tr_b16 v[224:225], v12 offset:4096
	ds_read_b64_tr_b16 v[226:227], v12 offset:6144
	v_mfma_f32_16x16x32_bf16 v[148:151], v[204:207], v[124:127], v[148:151]
	s_waitcnt lgkmcnt(7)
	v_exp_f32 v166, v166
	v_mfma_f32_16x16x32_bf16 v[136:139], v[208:211], v[128:131], v[136:139]
	ds_read_b64_tr_b16 v[228:229], v14 offset:4096
	ds_read_b64_tr_b16 v[230:231], v14 offset:6144
	v_mfma_f32_16x16x32_bf16 v[144:147], v[208:211], v[132:135], v[144:147]
	s_waitcnt lgkmcnt(8)
	v_exp_f32 v167, v167
	v_mfma_f32_16x16x32_bf16 v[140:143], v[212:215], v[128:131], v[140:143]
	v_cvt_pk_bf16_f32 v197, v162, v163
	v_cvt_pk_bf16_f32 v198, v164, v165
	v_mfma_f32_16x16x32_bf16 v[148:151], v[212:215], v[132:135], v[148:151]
	s_waitcnt lgkmcnt(6)
	v_cvt_pk_bf16_f32 v199, v166, v167
	v_mfma_f32_16x16x32_bf16 v[40:43], v[216:219], v[192:195], v[40:43]
	v_exp_f32 v136, v136
	v_mfma_f32_16x16x32_bf16 v[48:51], v[216:219], v[196:199], v[48:51]
	s_waitcnt lgkmcnt(4)
	v_exp_f32 v137, v137
	v_mfma_f32_16x16x32_bf16 v[56:59], v[220:223], v[192:195], v[56:59]
	ds_read_b64_tr_b16 v[232:233], v13 offset:0
	ds_read_b64_tr_b16 v[234:235], v13 offset:2048
	v_mfma_f32_16x16x32_bf16 v[64:67], v[220:223], v[196:199], v[64:67]
	s_waitcnt lgkmcnt(4)
	v_exp_f32 v138, v138
	v_mfma_f32_16x16x32_bf16 v[72:75], v[224:227], v[192:195], v[72:75]
	ds_read_b64_tr_b16 v[236:237], v15 offset:0
	ds_read_b64_tr_b16 v[238:239], v15 offset:2048
	v_mfma_f32_16x16x32_bf16 v[80:83], v[224:227], v[196:199], v[80:83]
	s_waitcnt lgkmcnt(4)
	v_exp_f32 v139, v139
	v_mfma_f32_16x16x32_bf16 v[88:91], v[228:231], v[192:195], v[88:91]
	ds_read_b64_tr_b16 v[240:241], v13 offset:4096
	ds_read_b64_tr_b16 v[242:243], v13 offset:6144
	v_mfma_f32_16x16x32_bf16 v[96:99], v[228:231], v[196:199], v[96:99]
	v_exp_f32 v140, v140
	v_mfma_f32_16x16x32_bf16 v[176:179], v[252:255], v[192:195], v[176:179]
	ds_read_b64_tr_b16 v[244:245], v15 offset:4096
	ds_read_b64_tr_b16 v[246:247], v15 offset:6144
	v_mfma_f32_16x16x32_bf16 v[180:183], v[252:255], v[196:199], v[180:183]
	s_waitcnt lgkmcnt(6)
	s_barrier
	ds_read_b128 v[248:251], v22 offset:8192
	v_mfma_f32_16x16x32_bf16 v[44:47], v[232:235], v[192:195], v[44:47]
	ds_read_b128 v[200:203], v22 offset:10240
	v_cvt_pk_bf16_f32 v184, v136, v137
	v_mfma_f32_16x16x32_bf16 v[52:55], v[232:235], v[196:199], v[52:55]
	s_waitcnt lgkmcnt(6)
	v_exp_f32 v141, v141
	v_mfma_f32_16x16x32_bf16 v[60:63], v[236:239], v[192:195], v[60:63]
	ds_read_b128 v[204:207], v23 offset:8192
	v_cvt_pk_bf16_f32 v185, v138, v139
	v_mfma_f32_16x16x32_bf16 v[68:71], v[236:239], v[196:199], v[68:71]
	s_waitcnt lgkmcnt(5)
	v_exp_f32 v142, v142
	v_mfma_f32_16x16x32_bf16 v[76:79], v[240:243], v[192:195], v[76:79]
	ds_read_b128 v[208:211], v23 offset:10240
	v_cvt_pk_bf16_f32 v186, v140, v141
	v_mfma_f32_16x16x32_bf16 v[84:87], v[240:243], v[196:199], v[84:87]
	s_waitcnt lgkmcnt(4)
	v_exp_f32 v143, v143
	v_mfma_f32_16x16x32_bf16 v[92:95], v[244:247], v[192:195], v[92:95]
	ds_read_b128 v[212:215], v22 offset:12288
	v_cvt_pk_bf16_f32 v187, v142, v143
	v_mfma_f32_16x16x32_bf16 v[100:103], v[244:247], v[196:199], v[100:103]
	s_waitcnt lgkmcnt(4)
	v_exp_f32 v144, v144
	v_mfma_f32_16x16x32_bf16 v[152:155], v[248:251], v[104:107], v[168:171]
	ds_read_b128 v[216:219], v22 offset:14336
	v_mfma_f32_16x16x32_bf16 v[160:163], v[248:251], v[108:111], v[172:175]
	s_waitcnt lgkmcnt(4)
	v_exp_f32 v145, v145
	v_mfma_f32_16x16x32_bf16 v[156:159], v[200:203], v[104:107], v[168:171]
	ds_read_b128 v[220:223], v23 offset:12288
	v_cvt_pk_bf16_f32 v188, v144, v145
	v_mfma_f32_16x16x32_bf16 v[164:167], v[200:203], v[108:111], v[172:175]
	s_waitcnt lgkmcnt(4)
	v_exp_f32 v146, v146
	v_mfma_f32_16x16x32_bf16 v[152:155], v[204:207], v[112:115], v[152:155]
	ds_read_b128 v[224:227], v23 offset:14336
	v_mfma_f32_16x16x32_bf16 v[160:163], v[204:207], v[116:119], v[160:163]
	s_waitcnt lgkmcnt(4)
	v_exp_f32 v147, v147
	v_mfma_f32_16x16x32_bf16 v[156:159], v[208:211], v[112:115], v[156:159]
	ds_read_b64_tr_b16 v[228:229], v12 offset:16384
	ds_read_b64_tr_b16 v[230:231], v12 offset:18432
	v_mfma_f32_16x16x32_bf16 v[164:167], v[208:211], v[116:119], v[164:167]
	s_waitcnt lgkmcnt(5)
	v_exp_f32 v148, v148
	v_mfma_f32_16x16x32_bf16 v[152:155], v[212:215], v[120:123], v[152:155]
	ds_read_b64_tr_b16 v[232:233], v14 offset:16384
	ds_read_b64_tr_b16 v[234:235], v14 offset:18432
	v_mfma_f32_16x16x32_bf16 v[160:163], v[212:215], v[124:127], v[160:163]
	s_waitcnt lgkmcnt(6)
	v_exp_f32 v149, v149
	v_mfma_f32_16x16x32_bf16 v[156:159], v[216:219], v[120:123], v[156:159]
	ds_read_b64_tr_b16 v[236:237], v12 offset:20480
	ds_read_b64_tr_b16 v[238:239], v12 offset:22528
	v_mfma_f32_16x16x32_bf16 v[164:167], v[216:219], v[124:127], v[164:167]
	s_waitcnt lgkmcnt(7)
	v_exp_f32 v150, v150
	v_mfma_f32_16x16x32_bf16 v[152:155], v[220:223], v[128:131], v[152:155]
	ds_read_b64_tr_b16 v[240:241], v14 offset:20480
	ds_read_b64_tr_b16 v[242:243], v14 offset:22528
	v_mfma_f32_16x16x32_bf16 v[160:163], v[220:223], v[132:135], v[160:163]
	s_waitcnt lgkmcnt(8)
	v_exp_f32 v151, v151
	v_mfma_f32_16x16x32_bf16 v[156:159], v[224:227], v[128:131], v[156:159]
	v_cvt_pk_bf16_f32 v189, v146, v147
	v_cvt_pk_bf16_f32 v190, v148, v149
	v_mfma_f32_16x16x32_bf16 v[164:167], v[224:227], v[132:135], v[164:167]
	s_waitcnt lgkmcnt(6)
	v_cvt_pk_bf16_f32 v191, v150, v151
	v_mfma_f32_16x16x32_bf16 v[40:43], v[228:231], v[184:187], v[40:43]
	v_exp_f32 v152, v152
	v_mfma_f32_16x16x32_bf16 v[48:51], v[228:231], v[188:191], v[48:51]
	s_waitcnt lgkmcnt(4)
	ds_read_b64_tr_b16 v[244:245], v13 offset:16384
	ds_read_b64_tr_b16 v[246:247], v13 offset:18432
	v_mfma_f32_16x16x32_bf16 v[56:59], v[232:235], v[184:187], v[56:59]
	v_exp_f32 v153, v153
	v_mfma_f32_16x16x32_bf16 v[64:67], v[232:235], v[188:191], v[64:67]
	s_waitcnt lgkmcnt(4)
	ds_read_b64_tr_b16 v[248:249], v15 offset:16384
	ds_read_b64_tr_b16 v[250:251], v15 offset:18432
	v_mfma_f32_16x16x32_bf16 v[72:75], v[236:239], v[184:187], v[72:75]
	v_exp_f32 v154, v154
	v_mfma_f32_16x16x32_bf16 v[80:83], v[236:239], v[188:191], v[80:83]
	s_waitcnt lgkmcnt(4)
	ds_read_b64_tr_b16 v[200:201], v13 offset:20480
	ds_read_b64_tr_b16 v[202:203], v13 offset:22528
	v_mfma_f32_16x16x32_bf16 v[88:91], v[240:243], v[184:187], v[88:91]
	v_exp_f32 v155, v155
	v_mfma_f32_16x16x32_bf16 v[96:99], v[240:243], v[188:191], v[96:99]
	ds_read_b64_tr_b16 v[204:205], v15 offset:20480
	ds_read_b64_tr_b16 v[206:207], v15 offset:22528
	v_mfma_f32_16x16x32_bf16 v[176:179], v[252:255], v[184:187], v[176:179]
	v_exp_f32 v156, v156
	v_mfma_f32_16x16x32_bf16 v[180:183], v[252:255], v[188:191], v[180:183]
	s_waitcnt lgkmcnt(6)
	s_barrier
	v_mfma_f32_16x16x32_bf16 v[44:47], v[244:247], v[184:187], v[44:47]
	v_exp_f32 v157, v157
	v_mfma_f32_16x16x32_bf16 v[52:55], v[244:247], v[188:191], v[52:55]
	s_waitcnt lgkmcnt(4)
	v_exp_f32 v158, v158
	v_mfma_f32_16x16x32_bf16 v[60:63], v[248:251], v[184:187], v[60:63]
	v_exp_f32 v159, v159
	v_mfma_f32_16x16x32_bf16 v[68:71], v[248:251], v[188:191], v[68:71]
	s_waitcnt lgkmcnt(2)
	v_cvt_pk_bf16_f32 v192, v152, v153
	v_cvt_pk_bf16_f32 v193, v154, v155
	v_mfma_f32_16x16x32_bf16 v[76:79], v[200:203], v[184:187], v[76:79]
	ds_read_b64_tr_b16 v[208:209], v12 offset:24576
	ds_read_b64_tr_b16 v[210:211], v12 offset:26624
	v_mfma_f32_16x16x32_bf16 v[84:87], v[200:203], v[188:191], v[84:87]
	s_waitcnt lgkmcnt(2)
	v_cvt_pk_bf16_f32 v194, v156, v157
	v_cvt_pk_bf16_f32 v195, v158, v159
	v_mfma_f32_16x16x32_bf16 v[92:95], v[204:207], v[184:187], v[92:95]
	v_exp_f32 v160, v160
	v_mfma_f32_16x16x32_bf16 v[100:103], v[204:207], v[188:191], v[100:103]
	s_waitcnt lgkmcnt(0)
	ds_read_b64_tr_b16 v[212:213], v13 offset:24576
	ds_read_b64_tr_b16 v[214:215], v13 offset:26624
	v_exp_f32 v161, v161
	ds_read_b64_tr_b16 v[216:217], v14 offset:24576
	v_exp_f32 v162, v162
	ds_read_b64_tr_b16 v[218:219], v14 offset:26624
	v_exp_f32 v163, v163
	v_exp_f32 v164, v164
	v_exp_f32 v165, v165
	v_exp_f32 v166, v166
	v_exp_f32 v167, v167
	ds_read_b64_tr_b16 v[220:221], v15 offset:24576
	ds_read_b64_tr_b16 v[222:223], v15 offset:26624
	v_cvt_pk_bf16_f32 v196, v160, v161
	v_cvt_pk_bf16_f32 v197, v162, v163
	v_cvt_pk_bf16_f32 v198, v164, v165
	v_cvt_pk_bf16_f32 v199, v166, v167
	v_mfma_f32_16x16x32_bf16 v[40:43], v[208:211], v[192:195], v[40:43]
	ds_read_b64_tr_b16 v[224:225], v12 offset:28672
	ds_read_b64_tr_b16 v[226:227], v12 offset:30720
	v_mfma_f32_16x16x32_bf16 v[48:51], v[208:211], v[196:199], v[48:51]
	v_mfma_f32_16x16x32_bf16 v[176:179], v[252:255], v[192:195], v[176:179]
	ds_read_b64_tr_b16 v[228:229], v13 offset:28672
	ds_read_b64_tr_b16 v[230:231], v13 offset:30720
	v_mfma_f32_16x16x32_bf16 v[180:183], v[252:255], v[196:199], v[180:183]
	s_waitcnt lgkmcnt(8)
	v_mfma_f32_16x16x32_bf16 v[44:47], v[212:215], v[192:195], v[44:47]
	ds_read_b64_tr_b16 v[232:233], v14 offset:28672
	ds_read_b64_tr_b16 v[234:235], v14 offset:30720
	v_mfma_f32_16x16x32_bf16 v[52:55], v[212:215], v[196:199], v[52:55]
	s_waitcnt lgkmcnt(8)
	v_rcp_f32 v177, v176
	v_mfma_f32_16x16x32_bf16 v[56:59], v[216:219], v[192:195], v[56:59]
	ds_read_b64_tr_b16 v[236:237], v15 offset:28672
	ds_read_b64_tr_b16 v[238:239], v15 offset:30720
	v_mfma_f32_16x16x32_bf16 v[64:67], v[216:219], v[196:199], v[64:67]
	s_waitcnt lgkmcnt(8)
	v_rcp_f32 v181, v180
	v_mfma_f32_16x16x32_bf16 v[60:63], v[220:223], v[192:195], v[60:63]
	v_subrev_u32 v6, 0x33800000, v176
	v_subrev_u32 v7, 0x33800000, v180
	v_mfma_f32_16x16x32_bf16 v[68:71], v[220:223], v[196:199], v[68:71]
	s_waitcnt lgkmcnt(6)
	v_max_u32 v6, v6, v7
	v_cmp_le_u32 vcc, 0x18000000, v6
	v_mfma_f32_16x16x32_bf16 v[72:75], v[224:227], v[192:195], v[72:75]
	v_mul_f32 v40, v40, v177
	v_mul_f32 v41, v41, v177
	v_mfma_f32_16x16x32_bf16 v[80:83], v[224:227], v[196:199], v[80:83]
	s_waitcnt lgkmcnt(4)
	s_and_b64 vcc, vcc, s[48:49]
	s_cselect_b32 s23, -1, 0
	v_mul_f32 v42, v42, v177
	v_mfma_f32_16x16x32_bf16 v[76:79], v[228:231], v[192:195], v[76:79]
	v_mul_f32 v43, v43, v177
	v_cvt_pk_bf16_f32 v136, v40, v41
	v_mfma_f32_16x16x32_bf16 v[84:87], v[228:231], v[196:199], v[84:87]
	s_waitcnt lgkmcnt(2)
	v_mul_f32 v44, v44, v177
	v_mul_f32 v45, v45, v177
	v_mfma_f32_16x16x32_bf16 v[88:91], v[232:235], v[192:195], v[88:91]
	v_mul_f32 v46, v46, v177
	v_mul_f32 v47, v47, v177
	v_mfma_f32_16x16x32_bf16 v[96:99], v[232:235], v[196:199], v[96:99]
	s_waitcnt lgkmcnt(0)
	v_mul_f32 v48, v48, v181
	v_mul_f32 v49, v49, v181
	v_mfma_f32_16x16x32_bf16 v[92:95], v[236:239], v[192:195], v[92:95]
	v_mul_f32 v50, v50, v181
	v_mul_f32 v51, v51, v181
	v_mfma_f32_16x16x32_bf16 v[100:103], v[236:239], v[196:199], v[100:103]
	ds_read_b64_tr_b16 v[240:241], v34 offset:0
	ds_read_b64_tr_b16 v[242:243], v34 offset:2048
	v_mul_f32 v52, v52, v181
	ds_read_b64_tr_b16 v[244:245], v35 offset:0
	v_mul_f32 v53, v53, v181
	v_mul_f32 v54, v54, v181
	ds_read_b64_tr_b16 v[246:247], v35 offset:2048
	v_mul_f32 v55, v55, v181
	v_mul_f32 v56, v56, v177
	v_mul_f32 v57, v57, v177
	v_mul_f32 v58, v58, v177
	v_mul_f32 v59, v59, v177
	v_mul_f32 v60, v60, v177
	v_mul_f32 v61, v61, v177
	v_mul_f32 v62, v62, v177
	v_mul_f32 v63, v63, v177
	v_mul_f32 v64, v64, v181
	v_mul_f32 v65, v65, v181
	v_mul_f32 v66, v66, v181
	v_mul_f32 v67, v67, v181
	v_mul_f32 v68, v68, v181
	v_mul_f32 v69, v69, v181
	v_mul_f32 v70, v70, v181
	v_mul_f32 v71, v71, v181
	v_mul_f32 v72, v72, v177
	v_mul_f32 v73, v73, v177
	v_mul_f32 v74, v74, v177
	v_mul_f32 v75, v75, v177
	v_mul_f32 v76, v76, v177
	v_mul_f32 v77, v77, v177
	v_mul_f32 v78, v78, v177
	v_mul_f32 v79, v79, v177
	v_mul_f32 v80, v80, v181
	v_mul_f32 v81, v81, v181
	v_mul_f32 v82, v82, v181
	v_mul_f32 v83, v83, v181
	v_mul_f32 v84, v84, v181
	v_mul_f32 v85, v85, v181
	v_mul_f32 v86, v86, v181
	v_mul_f32 v87, v87, v181
	v_mul_f32 v88, v88, v177
	v_mul_f32 v89, v89, v177
	v_mul_f32 v90, v90, v177
	v_mul_f32 v91, v91, v177
	v_mul_f32 v92, v92, v177
	v_mul_f32 v93, v93, v177
	v_mul_f32 v94, v94, v177
	v_mul_f32 v95, v95, v177
	v_mul_f32 v96, v96, v181
	v_mul_f32 v97, v97, v181
	v_mul_f32 v98, v98, v181
	v_mul_f32 v99, v99, v181
	v_mul_f32 v100, v100, v181
	v_mul_f32 v101, v101, v181
	v_mul_f32 v102, v102, v181
	v_mul_f32 v103, v103, v181
	v_cvt_pk_bf16_f32 v137, v42, v43
	v_cvt_pk_bf16_f32 v138, v44, v45
	v_cvt_pk_bf16_f32 v139, v46, v47
	v_cvt_pk_bf16_f32 v140, v48, v49
	v_cvt_pk_bf16_f32 v141, v50, v51
	v_cvt_pk_bf16_f32 v142, v52, v53
	v_cvt_pk_bf16_f32 v143, v54, v55
	v_or_b32 v136, s23, v136
	v_cvt_pk_bf16_f32 v144, v56, v57
	v_cvt_pk_bf16_f32 v145, v58, v59
	v_cvt_pk_bf16_f32 v146, v60, v61
	v_cvt_pk_bf16_f32 v147, v62, v63
	v_cvt_pk_bf16_f32 v148, v64, v65
	v_cvt_pk_bf16_f32 v149, v66, v67
	v_cvt_pk_bf16_f32 v150, v68, v69
	v_cvt_pk_bf16_f32 v151, v70, v71
	v_cvt_pk_bf16_f32 v152, v72, v73
	v_cvt_pk_bf16_f32 v153, v74, v75
	v_cvt_pk_bf16_f32 v154, v76, v77
	v_cvt_pk_bf16_f32 v155, v78, v79
	v_cvt_pk_bf16_f32 v156, v80, v81
	v_cvt_pk_bf16_f32 v157, v82, v83
	v_cvt_pk_bf16_f32 v158, v84, v85
	v_cvt_pk_bf16_f32 v159, v86, v87
	v_cvt_pk_bf16_f32 v160, v88, v89
	v_cvt_pk_bf16_f32 v161, v90, v91
	v_cvt_pk_bf16_f32 v162, v92, v93
	v_cvt_pk_bf16_f32 v163, v94, v95
	v_cvt_pk_bf16_f32 v164, v96, v97
	v_cvt_pk_bf16_f32 v165, v98, v99
	v_cvt_pk_bf16_f32 v166, v100, v101
	v_cvt_pk_bf16_f32 v167, v102, v103
	ds_write_b128 v3, v[136:139] offset:0
	ds_write_b128 v3, v[140:143] offset:1024
	ds_write_b128 v3, v[144:147] offset:2048
	ds_write_b128 v3, v[148:151] offset:3072
	ds_write_b128 v3, v[152:155] offset:4096
	ds_write_b128 v3, v[156:159] offset:5120
	ds_write_b128 v3, v[160:163] offset:6144
	ds_write_b128 v3, v[164:167] offset:7168
	s_waitcnt lgkmcnt(0)
	s_barrier
	v_mfma_f32_16x16x32_bf16 v[40:43], v[240:243], v[136:139], 0
	ds_read_b32 v6, v5
	v_add_u32 v5, 0x24400, v2
	v_mfma_f32_16x16x32_bf16 v[48:51], v[240:243], v[140:143], 0
	ds_read_b64_tr_b16 v[248:249], v34 offset:4096
	ds_read_b64_tr_b16 v[250:251], v34 offset:6144
	v_mfma_f32_16x16x32_bf16 v[44:47], v[244:247], v[136:139], 0
	ds_read_b64_tr_b16 v[200:201], v35 offset:4096
	v_cndmask_b32_e64 v2, v2, 2.0, s[94:95]
	v_mfma_f32_16x16x32_bf16 v[52:55], v[244:247], v[140:143], 0
	s_waitcnt lgkmcnt(1)
	ds_read_b64_tr_b16 v[202:203], v35 offset:6144
	ds_read_b128 v[168:171], v4 offset:0
	v_cndmask_b32_e64 v5, v5, 2.0, s[96:97]
	v_mov_b32 v3, 1
	ds_read_b128 v[172:175], v4 offset:1024
	ds_read_b128 v[176:179], v4 offset:2048
	ds_read_b128 v[180:183], v4 offset:3072
	s_waitcnt lgkmcnt(8)
	v_cmp_eq_u32 vcc, -1, v6
	s_and_b64 vcc, vcc, s[48:49]
	s_cbranch_scc1 L_redo_c
	v_mfma_f32_16x16x32_bf16 v[40:43], v[248:251], v[144:147], v[40:43]
	v_mfma_f32_16x16x32_bf16 v[48:51], v[248:251], v[148:151], v[48:51]
	s_waitcnt lgkmcnt(4)
	ds_read_b128 v[184:187], v4 offset:4096
	v_mfma_f32_16x16x32_bf16 v[44:47], v[200:203], v[144:147], v[44:47]
	ds_read_b128 v[188:191], v4 offset:5120
	v_mfma_f32_16x16x32_bf16 v[52:55], v[200:203], v[148:151], v[52:55]
	ds_read_b128 v[192:195], v4 offset:6144
	ds_read_b128 v[196:199], v4 offset:7168
	v_lshrrev_b32 v4, 4, v0
	v_lshl_add_u32 v4, v4, 10, v0
	v_lshlrev_b32 v4, 2, v4
	ds_read_b64_tr_b16 v[204:205], v34 offset:8192
	ds_read_b64_tr_b16 v[206:207], v34 offset:10240
	ds_read_b64_tr_b16 v[208:209], v35 offset:8192
	ds_read_b64_tr_b16 v[210:211], v35 offset:10240
	ds_read_b64_tr_b16 v[212:213], v34 offset:12288
	ds_read_b64_tr_b16 v[214:215], v34 offset:14336
	ds_read_b64_tr_b16 v[216:217], v35 offset:12288
	ds_read_b64_tr_b16 v[218:219], v35 offset:14336
	s_waitcnt lgkmcnt(8)
	s_barrier
	ds_read_b64_tr_b16 v[220:221], v36 offset:0
	ds_read_b64_tr_b16 v[222:223], v36 offset:2048
	s_waitcnt lgkmcnt(8)
	v_mfma_f32_16x16x32_bf16 v[40:43], v[204:207], v[152:155], v[40:43]
	ds_read_b64_tr_b16 v[224:225], v37 offset:0
	v_mfma_f32_16x16x32_bf16 v[48:51], v[204:207], v[156:159], v[48:51]
	s_waitcnt lgkmcnt(7)
	ds_read_b64_tr_b16 v[226:227], v37 offset:2048
	v_mfma_f32_16x16x32_bf16 v[44:47], v[208:211], v[152:155], v[44:47]
	ds_read_b64_tr_b16 v[228:229], v36 offset:4096
	ds_read_b64_tr_b16 v[230:231], v36 offset:6144
	v_mfma_f32_16x16x32_bf16 v[52:55], v[208:211], v[156:159], v[52:55]
	s_waitcnt lgkmcnt(8)
	v_mfma_f32_16x16x32_bf16 v[40:43], v[212:215], v[160:163], v[40:43]
	v_mfma_f32_16x16x32_bf16 v[48:51], v[212:215], v[164:167], v[48:51]
	s_waitcnt lgkmcnt(6)
	v_mfma_f32_16x16x32_bf16 v[44:47], v[216:219], v[160:163], v[44:47]
	ds_read_b64_tr_b16 v[232:233], v37 offset:4096
	ds_read_b64_tr_b16 v[234:235], v37 offset:6144
	v_mfma_f32_16x16x32_bf16 v[52:55], v[216:219], v[164:167], v[52:55]
	s_waitcnt lgkmcnt(6)
	v_mfma_f32_16x16x32_bf16 v[40:43], v[220:223], v[168:171], v[40:43]
	ds_read_b64_tr_b16 v[236:237], v36 offset:8192
	ds_read_b64_tr_b16 v[238:239], v36 offset:10240
	v_mfma_f32_16x16x32_bf16 v[48:51], v[220:223], v[172:175], v[48:51]
	s_waitcnt lgkmcnt(6)
	v_mfma_f32_16x16x32_bf16 v[44:47], v[224:227], v[168:171], v[44:47]
	ds_read_b64_tr_b16 v[240:241], v37 offset:8192
	ds_read_b64_tr_b16 v[242:243], v37 offset:10240
	v_mfma_f32_16x16x32_bf16 v[52:55], v[224:227], v[172:175], v[52:55]
	s_waitcnt lgkmcnt(6)
	v_mfma_f32_16x16x32_bf16 v[40:43], v[228:231], v[176:179], v[40:43]
	ds_read_b64_tr_b16 v[244:245], v36 offset:12288
	ds_read_b64_tr_b16 v[246:247], v36 offset:14336
	v_mfma_f32_16x16x32_bf16 v[48:51], v[228:231], v[180:183], v[48:51]
	s_waitcnt lgkmcnt(6)
	s_barrier
	ds_read_b64_tr_b16 v[248:249], v37 offset:12288
	ds_read_b64_tr_b16 v[250:251], v37 offset:14336
	v_mfma_f32_16x16x32_bf16 v[44:47], v[232:235], v[176:179], v[44:47]
	ds_read_b64_tr_b16 v[200:201], v26 offset:0
	v_mfma_f32_16x16x32_bf16 v[52:55], v[232:235], v[180:183], v[52:55]
	s_waitcnt lgkmcnt(7)
	ds_read_b64_tr_b16 v[202:203], v26 offset:2048
	v_mfma_f32_16x16x32_bf16 v[40:43], v[236:239], v[184:187], v[40:43]
	ds_read_b64_tr_b16 v[204:205], v27 offset:0
	ds_read_b64_tr_b16 v[206:207], v27 offset:2048
	v_mfma_f32_16x16x32_bf16 v[48:51], v[236:239], v[188:191], v[48:51]
	s_waitcnt lgkmcnt(8)
	v_mfma_f32_16x16x32_bf16 v[44:47], v[240:243], v[184:187], v[44:47]
	ds_read_b64_tr_b16 v[208:209], v26 offset:4096
	ds_read_b64_tr_b16 v[210:211], v26 offset:6144
	v_mfma_f32_16x16x32_bf16 v[52:55], v[240:243], v[188:191], v[52:55]
	s_waitcnt lgkmcnt(8)
	v_mfma_f32_16x16x32_bf16 v[40:43], v[244:247], v[192:195], v[40:43]
	ds_read_b64_tr_b16 v[212:213], v27 offset:4096
	ds_read_b64_tr_b16 v[214:215], v27 offset:6144
	s_nop 0
	v_mfma_f32_16x16x32_bf16 v[48:51], v[244:247], v[196:199], v[48:51]
	s_waitcnt lgkmcnt(8)
	s_nop 1
	v_mfma_f32_16x16x32_bf16 v[44:47], v[248:251], v[192:195], v[44:47]
	v_cvt_pk_bf16_f32 v72, v40, v41
	v_cvt_pk_bf16_f32 v73, v42, v43
	s_nop 0
	v_mfma_f32_16x16x32_bf16 v[52:55], v[248:251], v[196:199], v[52:55]
	s_waitcnt lgkmcnt(6)
	ds_read_b64_tr_b16 v[216:217], v26 offset:8192
	ds_read_b64_tr_b16 v[218:219], v26 offset:10240
	v_mfma_f32_16x16x32_bf16 v[56:59], v[200:203], v[136:139], 0
	v_cvt_pk_bf16_f32 v74, v44, v45
	v_cvt_pk_bf16_f32 v75, v46, v47
	v_mfma_f32_16x16x32_bf16 v[64:67], v[200:203], v[140:143], 0
	s_waitcnt lgkmcnt(6)
	ds_read_b64_tr_b16 v[220:221], v27 offset:8192
	ds_read_b64_tr_b16 v[222:223], v27 offset:10240
	v_mfma_f32_16x16x32_bf16 v[60:63], v[204:207], v[136:139], 0
	v_cvt_pk_bf16_f32 v76, v48, v49
	v_cvt_pk_bf16_f32 v77, v50, v51
	v_mfma_f32_16x16x32_bf16 v[68:71], v[204:207], v[140:143], 0
	s_waitcnt lgkmcnt(6)
	v_cvt_pk_bf16_f32 v78, v52, v53
	v_cvt_pk_bf16_f32 v79, v54, v55
	v_mfma_f32_16x16x32_bf16 v[56:59], v[208:211], v[144:147], v[56:59]
	ds_read_b64_tr_b16 v[224:225], v26 offset:12288
	ds_read_b64_tr_b16 v[226:227], v26 offset:14336
	v_mfma_f32_16x16x32_bf16 v[64:67], v[208:211], v[148:151], v[64:67]
	s_waitcnt lgkmcnt(6)
	v_mfma_f32_16x16x32_bf16 v[60:63], v[212:215], v[144:147], v[60:63]
	ds_read_b64_tr_b16 v[228:229], v27 offset:12288
	ds_read_b64_tr_b16 v[230:231], v27 offset:14336
	v_mfma_f32_16x16x32_bf16 v[68:71], v[212:215], v[148:151], v[68:71]
	s_waitcnt lgkmcnt(6)
	buffer_store_dwordx4 v[72:75], v2, s[44:47], s22 offen sc1
	v_mfma_f32_16x16x32_bf16 v[56:59], v[216:219], v[152:155], v[56:59]
	ds_read_b64_tr_b16 v[232:233], v28 offset:0
	ds_read_b64_tr_b16 v[234:235], v28 offset:2048
	v_mfma_f32_16x16x32_bf16 v[64:67], v[216:219], v[156:159], v[64:67]
	s_waitcnt lgkmcnt(6)
	ds_read_b64_tr_b16 v[236:237], v29 offset:0
	v_mfma_f32_16x16x32_bf16 v[60:63], v[220:223], v[152:155], v[60:63]
	ds_read_b64_tr_b16 v[238:239], v29 offset:2048
	v_mfma_f32_16x16x32_bf16 v[68:71], v[220:223], v[156:159], v[68:71]
	s_waitcnt lgkmcnt(6)
	buffer_store_dwordx4 v[76:79], v5, s[44:47], s22 offen sc1
	ds_read_b64_tr_b16 v[240:241], v28 offset:4096
	ds_read_b64_tr_b16 v[242:243], v28 offset:6144
	v_mfma_f32_16x16x32_bf16 v[56:59], v[224:227], v[160:163], v[56:59]
	s_add_u32 s22, s22, 8192
	s_cmp_eq_u32 s22, 73728
	s_cselect_b32 s22, 0, s22
	v_mfma_f32_16x16x32_bf16 v[64:67], v[224:227], v[164:167], v[64:67]
	s_waitcnt lgkmcnt(6)
	v_mfma_f32_16x16x32_bf16 v[60:63], v[228:231], v[160:163], v[60:63]
	ds_read_b64_tr_b16 v[244:245], v29 offset:4096
	ds_read_b64_tr_b16 v[246:247], v29 offset:6144
	v_mfma_f32_16x16x32_bf16 v[68:71], v[228:231], v[164:167], v[68:71]
	s_waitcnt lgkmcnt(6)
	v_mfma_f32_16x16x32_bf16 v[56:59], v[232:235], v[168:171], v[56:59]
	ds_read_b64_tr_b16 v[248:249], v28 offset:8192
	ds_read_b64_tr_b16 v[250:251], v28 offset:10240
	v_mfma_f32_16x16x32_bf16 v[64:67], v[232:235], v[172:175], v[64:67]
	s_waitcnt lgkmcnt(6)
	v_mfma_f32_16x16x32_bf16 v[60:63], v[236:239], v[168:171], v[60:63]
	ds_read_b64_tr_b16 v[200:201], v29 offset:8192
	ds_read_b64_tr_b16 v[202:203], v29 offset:10240
	v_mfma_f32_16x16x32_bf16 v[68:71], v[236:239], v[172:175], v[68:71]
	s_waitcnt lgkmcnt(6)
	v_mfma_f32_16x16x32_bf16 v[56:59], v[240:243], v[176:179], v[56:59]
	ds_read_b64_tr_b16 v[204:205], v28 offset:12288
	ds_read_b64_tr_b16 v[206:207], v28 offset:14336
	v_mfma_f32_16x16x32_bf16 v[64:67], v[240:243], v[180:183], v[64:67]
	s_waitcnt lgkmcnt(6)
	s_barrier
	ds_read_b64_tr_b16 v[208:209], v29 offset:12288
	ds_read_b64_tr_b16 v[210:211], v29 offset:14336
	v_mfma_f32_16x16x32_bf16 v[60:63], v[244:247], v[176:179], v[60:63]
	ds_read_b64_tr_b16 v[212:213], v26 offset:32768
	v_mfma_f32_16x16x32_bf16 v[68:71], v[244:247], v[180:183], v[68:71]
	s_waitcnt lgkmcnt(7)
	ds_read_b64_tr_b16 v[214:215], v26 offset:34816
	v_mfma_f32_16x16x32_bf16 v[56:59], v[248:251], v[184:187], v[56:59]
	ds_read_b64_tr_b16 v[216:217], v27 offset:32768
	ds_read_b64_tr_b16 v[218:219], v27 offset:34816
	v_mfma_f32_16x16x32_bf16 v[64:67], v[248:251], v[188:191], v[64:67]
	s_waitcnt lgkmcnt(8)
	v_mfma_f32_16x16x32_bf16 v[60:63], v[200:203], v[184:187], v[60:63]
	ds_read_b64_tr_b16 v[220:221], v26 offset:36864
	ds_read_b64_tr_b16 v[222:223], v26 offset:38912
	v_mfma_f32_16x16x32_bf16 v[68:71], v[200:203], v[188:191], v[68:71]
	s_waitcnt lgkmcnt(8)
	v_mfma_f32_16x16x32_bf16 v[56:59], v[204:207], v[192:195], v[56:59]
	ds_read_b64_tr_b16 v[224:225], v27 offset:36864
	ds_read_b64_tr_b16 v[226:227], v27 offset:38912
	s_nop 0
	v_mfma_f32_16x16x32_bf16 v[64:67], v[204:207], v[196:199], v[64:67]
	s_waitcnt lgkmcnt(8)
	s_nop 1
	v_mfma_f32_16x16x32_bf16 v[60:63], v[208:211], v[192:195], v[60:63]
	v_cvt_pk_bf16_f32 v80, v56, v57
	v_cvt_pk_bf16_f32 v81, v58, v59
	s_nop 0
	v_mfma_f32_16x16x32_bf16 v[68:71], v[208:211], v[196:199], v[68:71]
	s_waitcnt lgkmcnt(6)
	ds_read_b64_tr_b16 v[228:229], v26 offset:40960
	ds_read_b64_tr_b16 v[230:231], v26 offset:43008
	v_mfma_f32_16x16x32_bf16 v[40:43], v[212:215], v[136:139], 0
	v_cvt_pk_bf16_f32 v82, v60, v61
	v_cvt_pk_bf16_f32 v83, v62, v63
	v_mfma_f32_16x16x32_bf16 v[48:51], v[212:215], v[140:143], 0
	s_waitcnt lgkmcnt(6)
	ds_read_b64_tr_b16 v[232:233], v27 offset:40960
	ds_read_b64_tr_b16 v[234:235], v27 offset:43008
	v_mfma_f32_16x16x32_bf16 v[44:47], v[216:219], v[136:139], 0
	v_cvt_pk_bf16_f32 v84, v64, v65
	v_cvt_pk_bf16_f32 v85, v66, v67
	v_mfma_f32_16x16x32_bf16 v[52:55], v[216:219], v[140:143], 0
	s_waitcnt lgkmcnt(6)
	v_cvt_pk_bf16_f32 v86, v68, v69
	v_cvt_pk_bf16_f32 v87, v70, v71
	v_mfma_f32_16x16x32_bf16 v[40:43], v[220:223], v[144:147], v[40:43]
	ds_read_b64_tr_b16 v[236:237], v26 offset:45056
	ds_read_b64_tr_b16 v[238:239], v26 offset:47104
	v_mfma_f32_16x16x32_bf16 v[48:51], v[220:223], v[148:151], v[48:51]
	s_waitcnt lgkmcnt(6)
	v_mfma_f32_16x16x32_bf16 v[44:47], v[224:227], v[144:147], v[44:47]
	ds_read_b64_tr_b16 v[240:241], v27 offset:45056
	ds_read_b64_tr_b16 v[242:243], v27 offset:47104
	v_mfma_f32_16x16x32_bf16 v[52:55], v[224:227], v[148:151], v[52:55]
	s_waitcnt lgkmcnt(6)
	buffer_store_dwordx4 v[80:83], v2, s[44:47], s22 offen sc1
	v_mfma_f32_16x16x32_bf16 v[40:43], v[228:231], v[152:155], v[40:43]
	ds_read_b64_tr_b16 v[244:245], v28 offset:32768
	ds_read_b64_tr_b16 v[246:247], v28 offset:34816
	v_mfma_f32_16x16x32_bf16 v[48:51], v[228:231], v[156:159], v[48:51]
	s_waitcnt lgkmcnt(6)
	ds_read_b64_tr_b16 v[248:249], v29 offset:32768
	v_mfma_f32_16x16x32_bf16 v[44:47], v[232:235], v[152:155], v[44:47]
	ds_read_b64_tr_b16 v[250:251], v29 offset:34816
	v_mfma_f32_16x16x32_bf16 v[52:55], v[232:235], v[156:159], v[52:55]
	s_waitcnt lgkmcnt(6)
	buffer_store_dwordx4 v[84:87], v5, s[44:47], s22 offen sc1
	ds_read_b64_tr_b16 v[200:201], v28 offset:36864
	ds_read_b64_tr_b16 v[202:203], v28 offset:38912
	v_mfma_f32_16x16x32_bf16 v[40:43], v[236:239], v[160:163], v[40:43]
	s_add_u32 s22, s22, 8192
	s_cmp_eq_u32 s22, 73728
	s_cselect_b32 s22, 0, s22
	v_mfma_f32_16x16x32_bf16 v[48:51], v[236:239], v[164:167], v[48:51]
	s_waitcnt lgkmcnt(6)
	v_mfma_f32_16x16x32_bf16 v[44:47], v[240:243], v[160:163], v[44:47]
	ds_read_b64_tr_b16 v[204:205], v29 offset:36864
	ds_read_b64_tr_b16 v[206:207], v29 offset:38912
	v_mfma_f32_16x16x32_bf16 v[52:55], v[240:243], v[164:167], v[52:55]
	s_waitcnt lgkmcnt(6)
	v_mfma_f32_16x16x32_bf16 v[40:43], v[244:247], v[168:171], v[40:43]
	ds_read_b64_tr_b16 v[208:209], v28 offset:40960
	ds_read_b64_tr_b16 v[210:211], v28 offset:43008
	v_mfma_f32_16x16x32_bf16 v[48:51], v[244:247], v[172:175], v[48:51]
	s_waitcnt lgkmcnt(6)
	v_mfma_f32_16x16x32_bf16 v[44:47], v[248:251], v[168:171], v[44:47]
	ds_read_b64_tr_b16 v[212:213], v29 offset:40960
	ds_read_b64_tr_b16 v[214:215], v29 offset:43008
	v_mfma_f32_16x16x32_bf16 v[52:55], v[248:251], v[172:175], v[52:55]
	s_waitcnt lgkmcnt(6)
	v_mfma_f32_16x16x32_bf16 v[40:43], v[200:203], v[176:179], v[40:43]
	ds_read_b64_tr_b16 v[216:217], v28 offset:45056
	ds_read_b64_tr_b16 v[218:219], v28 offset:47104
	v_mfma_f32_16x16x32_bf16 v[48:51], v[200:203], v[180:183], v[48:51]
	s_waitcnt lgkmcnt(6)
	s_barrier
	ds_read_b64_tr_b16 v[220:221], v29 offset:45056
	ds_read_b64_tr_b16 v[222:223], v29 offset:47104
	v_mfma_f32_16x16x32_bf16 v[44:47], v[204:207], v[176:179], v[44:47]
	ds_read_b64_tr_b16 v[224:225], v30 offset:0
	v_mfma_f32_16x16x32_bf16 v[52:55], v[204:207], v[180:183], v[52:55]
	s_waitcnt lgkmcnt(7)
	ds_read_b64_tr_b16 v[226:227], v30 offset:2048
	v_mfma_f32_16x16x32_bf16 v[40:43], v[208:211], v[184:187], v[40:43]
	ds_read_b64_tr_b16 v[228:229], v31 offset:0
	ds_read_b64_tr_b16 v[230:231], v31 offset:2048
	v_mfma_f32_16x16x32_bf16 v[48:51], v[208:211], v[188:191], v[48:51]
	s_waitcnt lgkmcnt(8)
	v_mfma_f32_16x16x32_bf16 v[44:47], v[212:215], v[184:187], v[44:47]
	ds_read_b64_tr_b16 v[232:233], v30 offset:4096
	ds_read_b64_tr_b16 v[234:235], v30 offset:6144
	v_mfma_f32_16x16x32_bf16 v[52:55], v[212:215], v[188:191], v[52:55]
	s_waitcnt lgkmcnt(8)
	v_mfma_f32_16x16x32_bf16 v[40:43], v[216:219], v[192:195], v[40:43]
	ds_read_b64_tr_b16 v[236:237], v31 offset:4096
	ds_read_b64_tr_b16 v[238:239], v31 offset:6144
	s_nop 0
	v_mfma_f32_16x16x32_bf16 v[48:51], v[216:219], v[196:199], v[48:51]
	s_waitcnt lgkmcnt(8)
	s_nop 1
	v_mfma_f32_16x16x32_bf16 v[44:47], v[220:223], v[192:195], v[44:47]
	v_cvt_pk_bf16_f32 v88, v40, v41
	v_cvt_pk_bf16_f32 v89, v42, v43
	s_nop 0
	v_mfma_f32_16x16x32_bf16 v[52:55], v[220:223], v[196:199], v[52:55]
	s_waitcnt lgkmcnt(6)
	ds_read_b64_tr_b16 v[240:241], v30 offset:8192
	ds_read_b64_tr_b16 v[242:243], v30 offset:10240
	v_mfma_f32_16x16x32_bf16 v[56:59], v[224:227], v[136:139], 0
	v_cvt_pk_bf16_f32 v90, v44, v45
	v_cvt_pk_bf16_f32 v91, v46, v47
	v_mfma_f32_16x16x32_bf16 v[64:67], v[224:227], v[140:143], 0
	s_waitcnt lgkmcnt(6)
	ds_read_b64_tr_b16 v[244:245], v31 offset:8192
	ds_read_b64_tr_b16 v[246:247], v31 offset:10240
	v_mfma_f32_16x16x32_bf16 v[60:63], v[228:231], v[136:139], 0
	v_cvt_pk_bf16_f32 v92, v48, v49
	v_cvt_pk_bf16_f32 v93, v50, v51
	v_mfma_f32_16x16x32_bf16 v[68:71], v[228:231], v[140:143], 0
	s_waitcnt lgkmcnt(6)
	v_cvt_pk_bf16_f32 v94, v52, v53
	v_cvt_pk_bf16_f32 v95, v54, v55
	v_mfma_f32_16x16x32_bf16 v[56:59], v[232:235], v[144:147], v[56:59]
	ds_read_b64_tr_b16 v[248:249], v30 offset:12288
	ds_read_b64_tr_b16 v[250:251], v30 offset:14336
	v_mfma_f32_16x16x32_bf16 v[64:67], v[232:235], v[148:151], v[64:67]
	s_waitcnt lgkmcnt(6)
	v_mfma_f32_16x16x32_bf16 v[60:63], v[236:239], v[144:147], v[60:63]
	ds_read_b64_tr_b16 v[200:201], v31 offset:12288
	ds_read_b64_tr_b16 v[202:203], v31 offset:14336
	v_mfma_f32_16x16x32_bf16 v[68:71], v[236:239], v[148:151], v[68:71]
	s_waitcnt lgkmcnt(6)
	buffer_store_dwordx4 v[88:91], v2, s[44:47], s22 offen sc1
	v_mfma_f32_16x16x32_bf16 v[56:59], v[240:243], v[152:155], v[56:59]
	ds_read_b64_tr_b16 v[204:205], v32 offset:0
	ds_read_b64_tr_b16 v[206:207], v32 offset:2048
	v_mfma_f32_16x16x32_bf16 v[64:67], v[240:243], v[156:159], v[64:67]
	s_waitcnt lgkmcnt(6)
	ds_read_b64_tr_b16 v[208:209], v33 offset:0
	v_mfma_f32_16x16x32_bf16 v[60:63], v[244:247], v[152:155], v[60:63]
	ds_read_b64_tr_b16 v[210:211], v33 offset:2048
	v_mfma_f32_16x16x32_bf16 v[68:71], v[244:247], v[156:159], v[68:71]
	s_waitcnt lgkmcnt(6)
	buffer_store_dwordx4 v[92:95], v5, s[44:47], s22 offen sc1
	ds_read_b64_tr_b16 v[212:213], v32 offset:4096
	ds_read_b64_tr_b16 v[214:215], v32 offset:6144
	v_mfma_f32_16x16x32_bf16 v[56:59], v[248:251], v[160:163], v[56:59]
	s_add_u32 s22, s22, 8192
	s_cmp_eq_u32 s22, 73728
	s_cselect_b32 s22, 0, s22
	v_mfma_f32_16x16x32_bf16 v[64:67], v[248:251], v[164:167], v[64:67]
	s_waitcnt lgkmcnt(6)
	v_mfma_f32_16x16x32_bf16 v[60:63], v[200:203], v[160:163], v[60:63]
	ds_read_b64_tr_b16 v[216:217], v33 offset:4096
	ds_read_b64_tr_b16 v[218:219], v33 offset:6144
	v_mfma_f32_16x16x32_bf16 v[68:71], v[200:203], v[164:167], v[68:71]
	s_waitcnt lgkmcnt(6)
	v_mfma_f32_16x16x32_bf16 v[56:59], v[204:207], v[168:171], v[56:59]
	ds_read_b64_tr_b16 v[220:221], v32 offset:8192
	ds_read_b64_tr_b16 v[222:223], v32 offset:10240
	v_mfma_f32_16x16x32_bf16 v[64:67], v[204:207], v[172:175], v[64:67]
	s_waitcnt lgkmcnt(6)
	v_mfma_f32_16x16x32_bf16 v[60:63], v[208:211], v[168:171], v[60:63]
	ds_read_b64_tr_b16 v[224:225], v33 offset:8192
	ds_read_b64_tr_b16 v[226:227], v33 offset:10240
	v_mfma_f32_16x16x32_bf16 v[68:71], v[208:211], v[172:175], v[68:71]
	s_waitcnt lgkmcnt(6)
	v_mfma_f32_16x16x32_bf16 v[56:59], v[212:215], v[176:179], v[56:59]
	ds_read_b64_tr_b16 v[228:229], v32 offset:12288
	ds_read_b64_tr_b16 v[230:231], v32 offset:14336
	v_mfma_f32_16x16x32_bf16 v[64:67], v[212:215], v[180:183], v[64:67]
	s_waitcnt lgkmcnt(6)
	s_barrier
	ds_read_b64_tr_b16 v[232:233], v33 offset:12288
	ds_read_b64_tr_b16 v[234:235], v33 offset:14336
	v_mfma_f32_16x16x32_bf16 v[60:63], v[216:219], v[176:179], v[60:63]
	ds_read_b64_tr_b16 v[236:237], v30 offset:32768
	v_mfma_f32_16x16x32_bf16 v[68:71], v[216:219], v[180:183], v[68:71]
	s_waitcnt lgkmcnt(7)
	ds_read_b64_tr_b16 v[238:239], v30 offset:34816
	v_mfma_f32_16x16x32_bf16 v[56:59], v[220:223], v[184:187], v[56:59]
	ds_read_b64_tr_b16 v[240:241], v31 offset:32768
	ds_read_b64_tr_b16 v[242:243], v31 offset:34816
	v_mfma_f32_16x16x32_bf16 v[64:67], v[220:223], v[188:191], v[64:67]
	s_waitcnt lgkmcnt(8)
	v_mfma_f32_16x16x32_bf16 v[60:63], v[224:227], v[184:187], v[60:63]
	ds_read_b64_tr_b16 v[244:245], v30 offset:36864
	ds_read_b64_tr_b16 v[246:247], v30 offset:38912
	v_mfma_f32_16x16x32_bf16 v[68:71], v[224:227], v[188:191], v[68:71]
	s_waitcnt lgkmcnt(8)
	v_mfma_f32_16x16x32_bf16 v[56:59], v[228:231], v[192:195], v[56:59]
	ds_read_b64_tr_b16 v[248:249], v31 offset:36864
	ds_read_b64_tr_b16 v[250:251], v31 offset:38912
	s_nop 0
	v_mfma_f32_16x16x32_bf16 v[64:67], v[228:231], v[196:199], v[64:67]
	s_waitcnt lgkmcnt(8)
	s_nop 1
	v_mfma_f32_16x16x32_bf16 v[60:63], v[232:235], v[192:195], v[60:63]
	v_cvt_pk_bf16_f32 v96, v56, v57
	v_cvt_pk_bf16_f32 v97, v58, v59
	s_nop 0
	v_mfma_f32_16x16x32_bf16 v[68:71], v[232:235], v[196:199], v[68:71]
	s_waitcnt lgkmcnt(6)
	ds_read_b64_tr_b16 v[200:201], v30 offset:40960
	ds_read_b64_tr_b16 v[202:203], v30 offset:43008
	v_mfma_f32_16x16x32_bf16 v[40:43], v[236:239], v[136:139], 0
	v_cvt_pk_bf16_f32 v98, v60, v61
	v_cvt_pk_bf16_f32 v99, v62, v63
	v_mfma_f32_16x16x32_bf16 v[48:51], v[236:239], v[140:143], 0
	s_waitcnt lgkmcnt(6)
	ds_read_b64_tr_b16 v[204:205], v31 offset:40960
	ds_read_b64_tr_b16 v[206:207], v31 offset:43008
	v_mfma_f32_16x16x32_bf16 v[44:47], v[240:243], v[136:139], 0
	v_cvt_pk_bf16_f32 v100, v64, v65
	v_cvt_pk_bf16_f32 v101, v66, v67
	v_mfma_f32_16x16x32_bf16 v[52:55], v[240:243], v[140:143], 0
	s_waitcnt lgkmcnt(6)
	v_cvt_pk_bf16_f32 v102, v68, v69
	v_cvt_pk_bf16_f32 v103, v70, v71
	v_mfma_f32_16x16x32_bf16 v[40:43], v[244:247], v[144:147], v[40:43]
	ds_read_b64_tr_b16 v[208:209], v30 offset:45056
	ds_read_b64_tr_b16 v[210:211], v30 offset:47104
	v_mfma_f32_16x16x32_bf16 v[48:51], v[244:247], v[148:151], v[48:51]
	s_waitcnt lgkmcnt(6)
	v_mfma_f32_16x16x32_bf16 v[44:47], v[248:251], v[144:147], v[44:47]
	ds_read_b64_tr_b16 v[212:213], v31 offset:45056
	ds_read_b64_tr_b16 v[214:215], v31 offset:47104
	v_mfma_f32_16x16x32_bf16 v[52:55], v[248:251], v[148:151], v[52:55]
	s_waitcnt lgkmcnt(6)
	buffer_store_dwordx4 v[96:99], v2, s[44:47], s22 offen sc1
	v_mfma_f32_16x16x32_bf16 v[40:43], v[200:203], v[152:155], v[40:43]
	ds_read_b64_tr_b16 v[216:217], v32 offset:32768
	ds_read_b64_tr_b16 v[218:219], v32 offset:34816
	v_mfma_f32_16x16x32_bf16 v[48:51], v[200:203], v[156:159], v[48:51]
	s_waitcnt lgkmcnt(6)
	ds_read_b64_tr_b16 v[220:221], v33 offset:32768
	v_mfma_f32_16x16x32_bf16 v[44:47], v[204:207], v[152:155], v[44:47]
	ds_read_b64_tr_b16 v[222:223], v33 offset:34816
	v_mfma_f32_16x16x32_bf16 v[52:55], v[204:207], v[156:159], v[52:55]
	s_waitcnt lgkmcnt(6)
	buffer_store_dwordx4 v[100:103], v5, s[44:47], s22 offen sc1
	ds_read_b64_tr_b16 v[224:225], v32 offset:36864
	ds_read_b64_tr_b16 v[226:227], v32 offset:38912
	v_mfma_f32_16x16x32_bf16 v[40:43], v[208:211], v[160:163], v[40:43]
	s_add_u32 s22, s22, 8192
	s_cmp_eq_u32 s22, 73728
	s_cselect_b32 s22, 0, s22
	v_mfma_f32_16x16x32_bf16 v[48:51], v[208:211], v[164:167], v[48:51]
	s_waitcnt lgkmcnt(6)
	v_mfma_f32_16x16x32_bf16 v[44:47], v[212:215], v[160:163], v[44:47]
	ds_read_b64_tr_b16 v[228:229], v33 offset:36864
	ds_read_b64_tr_b16 v[230:231], v33 offset:38912
	v_mfma_f32_16x16x32_bf16 v[52:55], v[212:215], v[164:167], v[52:55]
	s_waitcnt lgkmcnt(6)
	v_mfma_f32_16x16x32_bf16 v[40:43], v[216:219], v[168:171], v[40:43]
	ds_read_b64_tr_b16 v[232:233], v32 offset:40960
	ds_read_b64_tr_b16 v[234:235], v32 offset:43008
	v_mfma_f32_16x16x32_bf16 v[48:51], v[216:219], v[172:175], v[48:51]
	s_waitcnt lgkmcnt(6)
	v_mfma_f32_16x16x32_bf16 v[44:47], v[220:223], v[168:171], v[44:47]
	ds_read_b64_tr_b16 v[236:237], v33 offset:40960
	ds_read_b64_tr_b16 v[238:239], v33 offset:43008
	v_mfma_f32_16x16x32_bf16 v[52:55], v[220:223], v[172:175], v[52:55]
	s_waitcnt lgkmcnt(6)
	v_mfma_f32_16x16x32_bf16 v[40:43], v[224:227], v[176:179], v[40:43]
	ds_read_b64_tr_b16 v[240:241], v32 offset:45056
	ds_read_b64_tr_b16 v[242:243], v32 offset:47104
	v_mfma_f32_16x16x32_bf16 v[48:51], v[224:227], v[180:183], v[48:51]
	s_waitcnt lgkmcnt(6)
	s_barrier
	ds_read_b64_tr_b16 v[244:245], v33 offset:45056
	ds_read_b64_tr_b16 v[246:247], v33 offset:47104
	v_mfma_f32_16x16x32_bf16 v[44:47], v[228:231], v[176:179], v[44:47]
	ds_read_b64_tr_b16 v[248:249], v34 offset:0
	v_mfma_f32_16x16x32_bf16 v[52:55], v[228:231], v[180:183], v[52:55]
	s_waitcnt lgkmcnt(7)
	ds_read_b64_tr_b16 v[250:251], v34 offset:2048
	v_mfma_f32_16x16x32_bf16 v[40:43], v[232:235], v[184:187], v[40:43]
	ds_read_b64_tr_b16 v[200:201], v35 offset:0
	ds_read_b64_tr_b16 v[202:203], v35 offset:2048
	v_mfma_f32_16x16x32_bf16 v[48:51], v[232:235], v[188:191], v[48:51]
	s_waitcnt lgkmcnt(8)
	v_mfma_f32_16x16x32_bf16 v[44:47], v[236:239], v[184:187], v[44:47]
	ds_read_b64_tr_b16 v[204:205], v34 offset:4096
	ds_read_b64_tr_b16 v[206:207], v34 offset:6144
	v_mfma_f32_16x16x32_bf16 v[52:55], v[236:239], v[188:191], v[52:55]
	s_waitcnt lgkmcnt(8)
	v_mfma_f32_16x16x32_bf16 v[40:43], v[240:243], v[192:195], v[40:43]
	ds_read_b64_tr_b16 v[208:209], v35 offset:4096
	ds_read_b64_tr_b16 v[210:211], v35 offset:6144
	s_nop 0
	v_mfma_f32_16x16x32_bf16 v[48:51], v[240:243], v[196:199], v[48:51]
	s_waitcnt lgkmcnt(8)
	s_nop 1
	v_mfma_f32_16x16x32_bf16 v[44:47], v[244:247], v[192:195], v[44:47]
	v_cvt_pk_bf16_f32 v104, v40, v41
	v_cvt_pk_bf16_f32 v105, v42, v43
	s_nop 0
	v_mfma_f32_16x16x32_bf16 v[52:55], v[244:247], v[196:199], v[52:55]
	s_waitcnt lgkmcnt(6)
	ds_read_b64_tr_b16 v[212:213], v34 offset:8192
	ds_read_b64_tr_b16 v[214:215], v34 offset:10240
	v_mfma_f32_16x16x32_bf16 v[56:59], v[248:251], v[136:139], 0
	v_cvt_pk_bf16_f32 v106, v44, v45
	v_cvt_pk_bf16_f32 v107, v46, v47
	v_mfma_f32_16x16x32_bf16 v[64:67], v[248:251], v[140:143], 0
	s_waitcnt lgkmcnt(6)
	ds_read_b64_tr_b16 v[216:217], v35 offset:8192
	ds_read_b64_tr_b16 v[218:219], v35 offset:10240
	v_mfma_f32_16x16x32_bf16 v[60:63], v[200:203], v[136:139], 0
	v_cvt_pk_bf16_f32 v108, v48, v49
	v_cvt_pk_bf16_f32 v109, v50, v51
	v_mfma_f32_16x16x32_bf16 v[68:71], v[200:203], v[140:143], 0
	s_waitcnt lgkmcnt(6)
	v_cvt_pk_bf16_f32 v110, v52, v53
	v_cvt_pk_bf16_f32 v111, v54, v55
	v_mfma_f32_16x16x32_bf16 v[56:59], v[204:207], v[144:147], v[56:59]
	ds_read_b64_tr_b16 v[220:221], v34 offset:12288
	ds_read_b64_tr_b16 v[222:223], v34 offset:14336
	v_mfma_f32_16x16x32_bf16 v[64:67], v[204:207], v[148:151], v[64:67]
	s_waitcnt lgkmcnt(6)
	v_mfma_f32_16x16x32_bf16 v[60:63], v[208:211], v[144:147], v[60:63]
	ds_read_b64_tr_b16 v[224:225], v35 offset:12288
	ds_read_b64_tr_b16 v[226:227], v35 offset:14336
	v_mfma_f32_16x16x32_bf16 v[68:71], v[208:211], v[148:151], v[68:71]
	s_waitcnt lgkmcnt(6)
	buffer_store_dwordx4 v[104:107], v2, s[44:47], s22 offen sc1
	v_mfma_f32_16x16x32_bf16 v[56:59], v[212:215], v[152:155], v[56:59]
	ds_read_b64_tr_b16 v[228:229], v36 offset:0
	ds_read_b64_tr_b16 v[230:231], v36 offset:2048
	v_mfma_f32_16x16x32_bf16 v[64:67], v[212:215], v[156:159], v[64:67]
	s_waitcnt lgkmcnt(6)
	ds_read_b64_tr_b16 v[232:233], v37 offset:0
	v_mfma_f32_16x16x32_bf16 v[60:63], v[216:219], v[152:155], v[60:63]
	ds_read_b64_tr_b16 v[234:235], v37 offset:2048
	v_mfma_f32_16x16x32_bf16 v[68:71], v[216:219], v[156:159], v[68:71]
	s_waitcnt lgkmcnt(6)
	buffer_store_dwordx4 v[108:111], v5, s[44:47], s22 offen sc1
	ds_read_b64_tr_b16 v[236:237], v36 offset:4096
	ds_read_b64_tr_b16 v[238:239], v36 offset:6144
	v_mfma_f32_16x16x32_bf16 v[56:59], v[220:223], v[160:163], v[56:59]
	s_add_u32 s22, s22, 8192
	s_cmp_eq_u32 s22, 73728
	s_cselect_b32 s22, 0, s22
	v_mfma_f32_16x16x32_bf16 v[64:67], v[220:223], v[164:167], v[64:67]
	s_waitcnt lgkmcnt(6)
	v_mfma_f32_16x16x32_bf16 v[60:63], v[224:227], v[160:163], v[60:63]
	ds_read_b64_tr_b16 v[240:241], v37 offset:4096
	ds_read_b64_tr_b16 v[242:243], v37 offset:6144
	v_mfma_f32_16x16x32_bf16 v[68:71], v[224:227], v[164:167], v[68:71]
	s_waitcnt lgkmcnt(6)
	v_mfma_f32_16x16x32_bf16 v[56:59], v[228:231], v[168:171], v[56:59]
	ds_read_b64_tr_b16 v[244:245], v36 offset:8192
	ds_read_b64_tr_b16 v[246:247], v36 offset:10240
	v_mfma_f32_16x16x32_bf16 v[64:67], v[228:231], v[172:175], v[64:67]
	s_waitcnt lgkmcnt(6)
	v_mfma_f32_16x16x32_bf16 v[60:63], v[232:235], v[168:171], v[60:63]
	ds_read_b64_tr_b16 v[248:249], v37 offset:8192
	ds_read_b64_tr_b16 v[250:251], v37 offset:10240
	v_mfma_f32_16x16x32_bf16 v[68:71], v[232:235], v[172:175], v[68:71]
	s_waitcnt lgkmcnt(6)
	v_mfma_f32_16x16x32_bf16 v[56:59], v[236:239], v[176:179], v[56:59]
	ds_read_b64_tr_b16 v[200:201], v36 offset:12288
	ds_read_b64_tr_b16 v[202:203], v36 offset:14336
	v_mfma_f32_16x16x32_bf16 v[64:67], v[236:239], v[180:183], v[64:67]
	s_waitcnt lgkmcnt(6)
	s_barrier
	ds_read_b64_tr_b16 v[204:205], v37 offset:12288
	ds_read_b64_tr_b16 v[206:207], v37 offset:14336
	v_mfma_f32_16x16x32_bf16 v[60:63], v[240:243], v[176:179], v[60:63]
	ds_read_b64_tr_b16 v[208:209], v26 offset:0
	v_mfma_f32_16x16x32_bf16 v[68:71], v[240:243], v[180:183], v[68:71]
	s_waitcnt lgkmcnt(7)
	ds_read_b64_tr_b16 v[210:211], v26 offset:2048
	v_mfma_f32_16x16x32_bf16 v[56:59], v[244:247], v[184:187], v[56:59]
	ds_read_b64_tr_b16 v[212:213], v27 offset:0
	ds_read_b64_tr_b16 v[214:215], v27 offset:2048
	v_mfma_f32_16x16x32_bf16 v[64:67], v[244:247], v[188:191], v[64:67]
	s_waitcnt lgkmcnt(8)
	v_mfma_f32_16x16x32_bf16 v[60:63], v[248:251], v[184:187], v[60:63]
	ds_read_b64_tr_b16 v[216:217], v26 offset:4096
	ds_read_b64_tr_b16 v[218:219], v26 offset:6144
	v_mfma_f32_16x16x32_bf16 v[68:71], v[248:251], v[188:191], v[68:71]
	s_waitcnt lgkmcnt(8)
	v_mfma_f32_16x16x32_bf16 v[56:59], v[200:203], v[192:195], v[56:59]
	ds_read_b64_tr_b16 v[220:221], v27 offset:4096
	ds_read_b64_tr_b16 v[222:223], v27 offset:6144
	s_nop 0
	v_mfma_f32_16x16x32_bf16 v[64:67], v[200:203], v[196:199], v[64:67]
	s_waitcnt lgkmcnt(8)
	s_nop 1
	v_mfma_f32_16x16x32_bf16 v[60:63], v[204:207], v[192:195], v[60:63]
	v_cvt_pk_bf16_f32 v112, v56, v57
	v_cvt_pk_bf16_f32 v113, v58, v59
	s_nop 0
	v_mfma_f32_16x16x32_bf16 v[68:71], v[204:207], v[196:199], v[68:71]
	s_waitcnt lgkmcnt(6)
	ds_read_b64_tr_b16 v[224:225], v26 offset:8192
	ds_read_b64_tr_b16 v[226:227], v26 offset:10240
	v_mfma_f32_16x16x32_bf16 v[40:43], v[208:211], v[136:139], 0
	v_cvt_pk_bf16_f32 v114, v60, v61
	v_cvt_pk_bf16_f32 v115, v62, v63
	v_mfma_f32_16x16x32_bf16 v[48:51], v[208:211], v[140:143], 0
	s_waitcnt lgkmcnt(6)
	ds_read_b64_tr_b16 v[228:229], v27 offset:8192
	ds_read_b64_tr_b16 v[230:231], v27 offset:10240
	v_mfma_f32_16x16x32_bf16 v[44:47], v[212:215], v[136:139], 0
	v_cvt_pk_bf16_f32 v116, v64, v65
	v_cvt_pk_bf16_f32 v117, v66, v67
	v_mfma_f32_16x16x32_bf16 v[52:55], v[212:215], v[140:143], 0
	s_waitcnt lgkmcnt(6)
	ds_read_b64_tr_b16 v[232:233], v26 offset:12288
	ds_read_b64_tr_b16 v[234:235], v26 offset:14336
	v_mfma_f32_16x16x32_bf16 v[40:43], v[216:219], v[144:147], v[40:43]
	v_cvt_pk_bf16_f32 v118, v68, v69
	v_cvt_pk_bf16_f32 v119, v70, v71
	v_mfma_f32_16x16x32_bf16 v[48:51], v[216:219], v[148:151], v[48:51]
	s_waitcnt lgkmcnt(6)
	ds_read_b64_tr_b16 v[236:237], v27 offset:12288
	ds_read_b64_tr_b16 v[238:239], v27 offset:14336
	v_mfma_f32_16x16x32_bf16 v[44:47], v[220:223], v[144:147], v[44:47]
	v_mfma_f32_16x16x32_bf16 v[52:55], v[220:223], v[148:151], v[52:55]
	s_waitcnt lgkmcnt(6)
	buffer_store_dwordx4 v[112:115], v2, s[44:47], s22 offen sc1
	v_mfma_f32_16x16x32_bf16 v[40:43], v[224:227], v[152:155], v[40:43]
	ds_read_b64_tr_b16 v[240:241], v28 offset:0
	ds_read_b64_tr_b16 v[242:243], v28 offset:2048
	v_mfma_f32_16x16x32_bf16 v[48:51], v[224:227], v[156:159], v[48:51]
	s_waitcnt lgkmcnt(6)
	ds_read_b64_tr_b16 v[244:245], v29 offset:0
	v_mfma_f32_16x16x32_bf16 v[44:47], v[228:231], v[152:155], v[44:47]
	ds_read_b64_tr_b16 v[246:247], v29 offset:2048
	v_mfma_f32_16x16x32_bf16 v[52:55], v[228:231], v[156:159], v[52:55]
	s_waitcnt lgkmcnt(6)
	buffer_store_dwordx4 v[116:119], v5, s[44:47], s22 offen sc1
	ds_read_b64_tr_b16 v[248:249], v28 offset:4096
	ds_read_b64_tr_b16 v[250:251], v28 offset:6144
	v_mfma_f32_16x16x32_bf16 v[40:43], v[232:235], v[160:163], v[40:43]
	s_add_u32 s22, s22, 8192
	s_cmp_eq_u32 s22, 73728
	s_cselect_b32 s22, 0, s22
	v_mfma_f32_16x16x32_bf16 v[48:51], v[232:235], v[164:167], v[48:51]
	s_waitcnt lgkmcnt(6)
	v_mfma_f32_16x16x32_bf16 v[44:47], v[236:239], v[160:163], v[44:47]
	ds_read_b64_tr_b16 v[200:201], v29 offset:4096
	ds_read_b64_tr_b16 v[202:203], v29 offset:6144
	v_mfma_f32_16x16x32_bf16 v[52:55], v[236:239], v[164:167], v[52:55]
	s_waitcnt lgkmcnt(6)
	s_waitcnt vmcnt(4)
	buffer_store_dword v3, v4, s[32:35], 0 offen offset:0 sc1
	v_mfma_f32_16x16x32_bf16 v[40:43], v[240:243], v[168:171], v[40:43]
	ds_read_b64_tr_b16 v[204:205], v28 offset:8192
	ds_read_b64_tr_b16 v[206:207], v28 offset:10240
	v_mfma_f32_16x16x32_bf16 v[48:51], v[240:243], v[172:175], v[48:51]
	s_waitcnt lgkmcnt(6)
	v_mfma_f32_16x16x32_bf16 v[44:47], v[244:247], v[168:171], v[44:47]
	ds_read_b64_tr_b16 v[208:209], v29 offset:8192
	ds_read_b64_tr_b16 v[210:211], v29 offset:10240
	v_mfma_f32_16x16x32_bf16 v[52:55], v[244:247], v[172:175], v[52:55]
	s_waitcnt lgkmcnt(6)
	v_mfma_f32_16x16x32_bf16 v[40:43], v[248:251], v[176:179], v[40:43]
	ds_read_b64_tr_b16 v[212:213], v28 offset:12288
	ds_read_b64_tr_b16 v[214:215], v28 offset:14336
	v_mfma_f32_16x16x32_bf16 v[48:51], v[248:251], v[180:183], v[48:51]
	s_waitcnt lgkmcnt(6)
	s_barrier
	ds_read_b64_tr_b16 v[216:217], v29 offset:12288
	ds_read_b64_tr_b16 v[218:219], v29 offset:14336
	v_mfma_f32_16x16x32_bf16 v[44:47], v[200:203], v[176:179], v[44:47]
	ds_read_b64_tr_b16 v[220:221], v26 offset:32768
	v_mfma_f32_16x16x32_bf16 v[52:55], v[200:203], v[180:183], v[52:55]
	s_waitcnt lgkmcnt(7)
	ds_read_b64_tr_b16 v[222:223], v26 offset:34816
	v_mfma_f32_16x16x32_bf16 v[40:43], v[204:207], v[184:187], v[40:43]
	ds_read_b64_tr_b16 v[224:225], v27 offset:32768
	ds_read_b64_tr_b16 v[226:227], v27 offset:34816
	v_mfma_f32_16x16x32_bf16 v[48:51], v[204:207], v[188:191], v[48:51]
	s_waitcnt lgkmcnt(8)
	v_mfma_f32_16x16x32_bf16 v[44:47], v[208:211], v[184:187], v[44:47]
	ds_read_b64_tr_b16 v[228:229], v26 offset:36864
	ds_read_b64_tr_b16 v[230:231], v26 offset:38912
	v_mfma_f32_16x16x32_bf16 v[52:55], v[208:211], v[188:191], v[52:55]
	s_waitcnt lgkmcnt(8)
	v_mfma_f32_16x16x32_bf16 v[40:43], v[212:215], v[192:195], v[40:43]
	ds_read_b64_tr_b16 v[232:233], v27 offset:36864
	ds_read_b64_tr_b16 v[234:235], v27 offset:38912
	s_nop 0
	v_mfma_f32_16x16x32_bf16 v[48:51], v[212:215], v[196:199], v[48:51]
	s_waitcnt lgkmcnt(8)
	s_nop 1
	v_mfma_f32_16x16x32_bf16 v[44:47], v[216:219], v[192:195], v[44:47]
	v_cvt_pk_bf16_f32 v120, v40, v41
	v_cvt_pk_bf16_f32 v121, v42, v43
	s_nop 0
	v_mfma_f32_16x16x32_bf16 v[52:55], v[216:219], v[196:199], v[52:55]
	s_waitcnt lgkmcnt(6)
	ds_read_b64_tr_b16 v[236:237], v26 offset:40960
	ds_read_b64_tr_b16 v[238:239], v26 offset:43008
	v_mfma_f32_16x16x32_bf16 v[56:59], v[220:223], v[136:139], 0
	v_cvt_pk_bf16_f32 v122, v44, v45
	v_cvt_pk_bf16_f32 v123, v46, v47
	v_mfma_f32_16x16x32_bf16 v[64:67], v[220:223], v[140:143], 0
	s_waitcnt lgkmcnt(6)
	ds_read_b64_tr_b16 v[240:241], v27 offset:40960
	ds_read_b64_tr_b16 v[242:243], v27 offset:43008
	v_mfma_f32_16x16x32_bf16 v[60:63], v[224:227], v[136:139], 0
	v_cvt_pk_bf16_f32 v124, v48, v49
	v_cvt_pk_bf16_f32 v125, v50, v51
	v_mfma_f32_16x16x32_bf16 v[68:71], v[224:227], v[140:143], 0
	s_waitcnt lgkmcnt(6)
	v_cvt_pk_bf16_f32 v126, v52, v53
	v_cvt_pk_bf16_f32 v127, v54, v55
	v_mfma_f32_16x16x32_bf16 v[56:59], v[228:231], v[144:147], v[56:59]
	ds_read_b64_tr_b16 v[244:245], v26 offset:45056
	ds_read_b64_tr_b16 v[246:247], v26 offset:47104
	v_mfma_f32_16x16x32_bf16 v[64:67], v[228:231], v[148:151], v[64:67]
	s_waitcnt lgkmcnt(6)
	v_mfma_f32_16x16x32_bf16 v[60:63], v[232:235], v[144:147], v[60:63]
	ds_read_b64_tr_b16 v[248:249], v27 offset:45056
	ds_read_b64_tr_b16 v[250:251], v27 offset:47104
	v_mfma_f32_16x16x32_bf16 v[68:71], v[232:235], v[148:151], v[68:71]
	s_waitcnt lgkmcnt(6)
	buffer_store_dwordx4 v[120:123], v2, s[44:47], s22 offen sc1
	v_mfma_f32_16x16x32_bf16 v[56:59], v[236:239], v[152:155], v[56:59]
	ds_read_b64_tr_b16 v[200:201], v28 offset:32768
	ds_read_b64_tr_b16 v[202:203], v28 offset:34816
	v_mfma_f32_16x16x32_bf16 v[64:67], v[236:239], v[156:159], v[64:67]
	s_waitcnt lgkmcnt(6)
	ds_read_b64_tr_b16 v[204:205], v29 offset:32768
	v_mfma_f32_16x16x32_bf16 v[60:63], v[240:243], v[152:155], v[60:63]
	ds_read_b64_tr_b16 v[206:207], v29 offset:34816
	v_mfma_f32_16x16x32_bf16 v[68:71], v[240:243], v[156:159], v[68:71]
	s_waitcnt lgkmcnt(6)
	buffer_store_dwordx4 v[124:127], v5, s[44:47], s22 offen sc1
	ds_read_b64_tr_b16 v[208:209], v28 offset:36864
	ds_read_b64_tr_b16 v[210:211], v28 offset:38912
	v_mfma_f32_16x16x32_bf16 v[56:59], v[244:247], v[160:163], v[56:59]
	s_add_u32 s22, s22, 8192
	s_cmp_eq_u32 s22, 73728
	s_cselect_b32 s22, 0, s22
	v_mfma_f32_16x16x32_bf16 v[64:67], v[244:247], v[164:167], v[64:67]
	s_waitcnt lgkmcnt(6)
	v_mfma_f32_16x16x32_bf16 v[60:63], v[248:251], v[160:163], v[60:63]
	ds_read_b64_tr_b16 v[212:213], v29 offset:36864
	ds_read_b64_tr_b16 v[214:215], v29 offset:38912
	v_mfma_f32_16x16x32_bf16 v[68:71], v[248:251], v[164:167], v[68:71]
	s_waitcnt lgkmcnt(6)
	v_mfma_f32_16x16x32_bf16 v[56:59], v[200:203], v[168:171], v[56:59]
	ds_read_b64_tr_b16 v[216:217], v28 offset:40960
	ds_read_b64_tr_b16 v[218:219], v28 offset:43008
	v_mfma_f32_16x16x32_bf16 v[64:67], v[200:203], v[172:175], v[64:67]
	s_waitcnt lgkmcnt(6)
	v_mfma_f32_16x16x32_bf16 v[60:63], v[204:207], v[168:171], v[60:63]
	ds_read_b64_tr_b16 v[220:221], v29 offset:40960
	ds_read_b64_tr_b16 v[222:223], v29 offset:43008
	v_mfma_f32_16x16x32_bf16 v[68:71], v[204:207], v[172:175], v[68:71]
	s_waitcnt lgkmcnt(6)
	v_mfma_f32_16x16x32_bf16 v[56:59], v[208:211], v[176:179], v[56:59]
	ds_read_b64_tr_b16 v[224:225], v28 offset:45056
	ds_read_b64_tr_b16 v[226:227], v28 offset:47104
	v_mfma_f32_16x16x32_bf16 v[64:67], v[208:211], v[180:183], v[64:67]
	s_waitcnt lgkmcnt(6)
	s_barrier
	ds_read_b64_tr_b16 v[228:229], v29 offset:45056
	ds_read_b64_tr_b16 v[230:231], v29 offset:47104
	v_mfma_f32_16x16x32_bf16 v[60:63], v[212:215], v[176:179], v[60:63]
	ds_read_b64_tr_b16 v[232:233], v30 offset:0
	v_mfma_f32_16x16x32_bf16 v[68:71], v[212:215], v[180:183], v[68:71]
	s_waitcnt lgkmcnt(7)
	ds_read_b64_tr_b16 v[234:235], v30 offset:2048
	v_mfma_f32_16x16x32_bf16 v[56:59], v[216:219], v[184:187], v[56:59]
	ds_read_b64_tr_b16 v[236:237], v31 offset:0
	ds_read_b64_tr_b16 v[238:239], v31 offset:2048
	v_mfma_f32_16x16x32_bf16 v[64:67], v[216:219], v[188:191], v[64:67]
	s_waitcnt lgkmcnt(8)
	v_mfma_f32_16x16x32_bf16 v[60:63], v[220:223], v[184:187], v[60:63]
	ds_read_b64_tr_b16 v[240:241], v30 offset:4096
	ds_read_b64_tr_b16 v[242:243], v30 offset:6144
	v_mfma_f32_16x16x32_bf16 v[68:71], v[220:223], v[188:191], v[68:71]
	s_waitcnt lgkmcnt(8)
	v_mfma_f32_16x16x32_bf16 v[56:59], v[224:227], v[192:195], v[56:59]
	ds_read_b64_tr_b16 v[244:245], v31 offset:4096
	ds_read_b64_tr_b16 v[246:247], v31 offset:6144
	s_nop 0
	v_mfma_f32_16x16x32_bf16 v[64:67], v[224:227], v[196:199], v[64:67]
	s_waitcnt lgkmcnt(8)
	s_nop 1
	v_mfma_f32_16x16x32_bf16 v[60:63], v[228:231], v[192:195], v[60:63]
	v_cvt_pk_bf16_f32 v128, v56, v57
	v_cvt_pk_bf16_f32 v129, v58, v59
	s_nop 0
	v_mfma_f32_16x16x32_bf16 v[68:71], v[228:231], v[196:199], v[68:71]
	s_waitcnt lgkmcnt(6)
	ds_read_b64_tr_b16 v[248:249], v30 offset:8192
	ds_read_b64_tr_b16 v[250:251], v30 offset:10240
	v_mfma_f32_16x16x32_bf16 v[40:43], v[232:235], v[136:139], 0
	v_cvt_pk_bf16_f32 v130, v60, v61
	v_cvt_pk_bf16_f32 v131, v62, v63
	v_mfma_f32_16x16x32_bf16 v[48:51], v[232:235], v[140:143], 0
	s_waitcnt lgkmcnt(6)
	ds_read_b64_tr_b16 v[200:201], v31 offset:8192
	ds_read_b64_tr_b16 v[202:203], v31 offset:10240
	v_mfma_f32_16x16x32_bf16 v[44:47], v[236:239], v[136:139], 0
	v_cvt_pk_bf16_f32 v132, v64, v65
	v_cvt_pk_bf16_f32 v133, v66, v67
	v_mfma_f32_16x16x32_bf16 v[52:55], v[236:239], v[140:143], 0
	s_waitcnt lgkmcnt(6)
	v_cvt_pk_bf16_f32 v134, v68, v69
	v_cvt_pk_bf16_f32 v135, v70, v71
	v_mfma_f32_16x16x32_bf16 v[40:43], v[240:243], v[144:147], v[40:43]
	ds_read_b64_tr_b16 v[204:205], v30 offset:12288
	ds_read_b64_tr_b16 v[206:207], v30 offset:14336
	v_mfma_f32_16x16x32_bf16 v[48:51], v[240:243], v[148:151], v[48:51]
	s_waitcnt lgkmcnt(6)
	v_mfma_f32_16x16x32_bf16 v[44:47], v[244:247], v[144:147], v[44:47]
	ds_read_b64_tr_b16 v[208:209], v31 offset:12288
	ds_read_b64_tr_b16 v[210:211], v31 offset:14336
	v_mfma_f32_16x16x32_bf16 v[52:55], v[244:247], v[148:151], v[52:55]
	s_waitcnt lgkmcnt(6)
	buffer_store_dwordx4 v[128:131], v2, s[44:47], s22 offen sc1
	v_mfma_f32_16x16x32_bf16 v[40:43], v[248:251], v[152:155], v[40:43]
	ds_read_b64_tr_b16 v[212:213], v32 offset:0
	ds_read_b64_tr_b16 v[214:215], v32 offset:2048
	v_mfma_f32_16x16x32_bf16 v[48:51], v[248:251], v[156:159], v[48:51]
	s_waitcnt lgkmcnt(6)
	ds_read_b64_tr_b16 v[216:217], v33 offset:0
	v_mfma_f32_16x16x32_bf16 v[44:47], v[200:203], v[152:155], v[44:47]
	ds_read_b64_tr_b16 v[218:219], v33 offset:2048
	v_mfma_f32_16x16x32_bf16 v[52:55], v[200:203], v[156:159], v[52:55]
	s_waitcnt lgkmcnt(6)
	buffer_store_dwordx4 v[132:135], v5, s[44:47], s22 offen sc1
	ds_read_b64_tr_b16 v[220:221], v32 offset:4096
	ds_read_b64_tr_b16 v[222:223], v32 offset:6144
	v_mfma_f32_16x16x32_bf16 v[40:43], v[204:207], v[160:163], v[40:43]
	ds_read_b64_tr_b16 v[224:225], v33 offset:4096
	s_add_u32 s22, s22, 8192
	v_mfma_f32_16x16x32_bf16 v[48:51], v[204:207], v[164:167], v[48:51]
	s_waitcnt lgkmcnt(7)
	ds_read_b64_tr_b16 v[226:227], v33 offset:6144
	v_mfma_f32_16x16x32_bf16 v[44:47], v[208:211], v[160:163], v[44:47]
	ds_read_b64_tr_b16 v[228:229], v32 offset:8192
	ds_read_b64_tr_b16 v[230:231], v32 offset:10240
	v_mfma_f32_16x16x32_bf16 v[52:55], v[208:211], v[164:167], v[52:55]
	s_waitcnt lgkmcnt(8)
	s_cmp_eq_u32 s22, 73728
	s_cselect_b32 s22, 0, s22
	v_mfma_f32_16x16x32_bf16 v[40:43], v[212:215], v[168:171], v[40:43]
	ds_read_b64_tr_b16 v[232:233], v33 offset:8192
	ds_read_b64_tr_b16 v[234:235], v33 offset:10240
	v_mfma_f32_16x16x32_bf16 v[48:51], v[212:215], v[172:175], v[48:51]
	s_waitcnt lgkmcnt(8)
	v_mfma_f32_16x16x32_bf16 v[44:47], v[216:219], v[168:171], v[44:47]
	ds_read_b64_tr_b16 v[236:237], v32 offset:12288
	ds_read_b64_tr_b16 v[238:239], v32 offset:14336
	v_mfma_f32_16x16x32_bf16 v[52:55], v[216:219], v[172:175], v[52:55]
	s_waitcnt lgkmcnt(8)
	v_mfma_f32_16x16x32_bf16 v[40:43], v[220:223], v[176:179], v[40:43]
	ds_read_b64_tr_b16 v[240:241], v33 offset:12288
	ds_read_b64_tr_b16 v[242:243], v33 offset:14336
	v_mfma_f32_16x16x32_bf16 v[48:51], v[220:223], v[180:183], v[48:51]
	s_waitcnt lgkmcnt(8)
	v_mfma_f32_16x16x32_bf16 v[44:47], v[224:227], v[176:179], v[44:47]
	v_mfma_f32_16x16x32_bf16 v[52:55], v[224:227], v[180:183], v[52:55]
	s_waitcnt lgkmcnt(6)
	v_mfma_f32_16x16x32_bf16 v[40:43], v[228:231], v[184:187], v[40:43]
	v_mfma_f32_16x16x32_bf16 v[48:51], v[228:231], v[188:191], v[48:51]
	s_waitcnt lgkmcnt(4)
	v_mfma_f32_16x16x32_bf16 v[44:47], v[232:235], v[184:187], v[44:47]
	v_mfma_f32_16x16x32_bf16 v[52:55], v[232:235], v[188:191], v[52:55]
	s_waitcnt lgkmcnt(2)
	v_mfma_f32_16x16x32_bf16 v[40:43], v[236:239], v[192:195], v[40:43]
	s_nop 2
	v_mfma_f32_16x16x32_bf16 v[48:51], v[236:239], v[196:199], v[48:51]
	s_waitcnt lgkmcnt(0)
	s_nop 1
	v_mfma_f32_16x16x32_bf16 v[44:47], v[240:243], v[192:195], v[44:47]
	v_cvt_pk_bf16_f32 v8, v40, v41
	v_cvt_pk_bf16_f32 v9, v42, v43
	s_nop 0
	v_mfma_f32_16x16x32_bf16 v[52:55], v[240:243], v[196:199], v[52:55]
	v_cvt_pk_bf16_f32 v12, v48, v49
	v_cvt_pk_bf16_f32 v13, v50, v51
	s_nop 1
	v_cvt_pk_bf16_f32 v10, v44, v45
	v_cvt_pk_bf16_f32 v11, v46, v47
	buffer_store_dwordx4 v[8:11], v2, s[44:47], s22 offen sc1
	s_nop 0
	v_cvt_pk_bf16_f32 v14, v52, v53
	v_cvt_pk_bf16_f32 v15, v54, v55
	buffer_store_dwordx4 v[12:15], v5, s[44:47], s22 offen sc1
	s_waitcnt vmcnt(0)
	buffer_store_dword v3, v4, s[32:35], 0 offen offset:64 sc1
s_or_b64 exec, s[94:95], s[96:97]
s_cbranch_execz L_end1
s_lshr_b32 s63, s65, 4
s_add_u32 s63, s63, 143360
v_and_b32 v1, 7, v0
v_lshrrev_b32 v0, 4, v0
v_lshl_add_u32 v1, v0, 3, v1
v_lshl_add_u32 v1, v1, 4, s63
s_cmp_eq_u64 s[94:95], 0
s_cbranch_scc1 L_own1
ds_write_b128 v1, v[72:75] offset:0
ds_write_b128 v1, v[80:83] offset:512
ds_write_b128 v1, v[88:91] offset:1024
ds_write_b128 v1, v[96:99] offset:1536
ds_write_b128 v1, v[104:107] offset:2048
ds_write_b128 v1, v[112:115] offset:2560
ds_write_b128 v1, v[120:123] offset:3072
ds_write_b128 v1, v[128:131] offset:3584
ds_write_b128 v1, v[8:11] offset:4096
s_waitcnt lgkmcnt(0)
s_endpgm
L_own1:
ds_write_b128 v1, v[76:79] offset:0
ds_write_b128 v1, v[84:87] offset:512
ds_write_b128 v1, v[92:95] offset:1024
ds_write_b128 v1, v[100:103] offset:1536
ds_write_b128 v1, v[108:111] offset:2048
ds_write_b128 v1, v[116:119] offset:2560
ds_write_b128 v1, v[124:127] offset:3072
ds_write_b128 v1, v[132:135] offset:3584
ds_write_b128 v1, v[12:15] offset:4096
s_waitcnt lgkmcnt(0)
L_end1:
s_endpgm
L_redo_c:
s_waitcnt lgkmcnt(0)
s_nop 7
s_nop 7
v_bfe_u32 v6, v0, 4, 1
v_lshrrev_b32 v7, 5, v0
v_lshl_or_b32 v7, v6, 1, v7
v_lshlrev_b32 v7, 4, v7
v_and_b32 v6, 15, v0
v_lshl_add_u32 v6, v6, 8, v7
v_add_u32 v7, 4096, v6
v_mov_b32 v38, 0xff800000
v_mov_b32 v1, 0xff800000
s_mov_b32 s22, 0
L_redo_loop:
buffer_load_dwordx4 v[200:203], v6, s[28:31], s22 offen offset:0
buffer_load_dwordx4 v[204:207], v7, s[28:31], s22 offen offset:0
buffer_load_dwordx4 v[208:211], v6, s[28:31], s22 offen offset:64
buffer_load_dwordx4 v[212:215], v7, s[28:31], s22 offen offset:64
buffer_load_dwordx4 v[216:219], v6, s[28:31], s22 offen offset:128
buffer_load_dwordx4 v[220:223], v7, s[28:31], s22 offen offset:128
buffer_load_dwordx4 v[224:227], v6, s[28:31], s22 offen offset:192
buffer_load_dwordx4 v[228:231], v7, s[28:31], s22 offen offset:192
s_waitcnt vmcnt(0)
v_mfma_f32_16x16x32_bf16 v[40:43], v[200:203], v[104:107], 0
v_mfma_f32_16x16x32_bf16 v[48:51], v[200:203], v[108:111], 0
v_mfma_f32_16x16x32_bf16 v[44:47], v[204:207], v[104:107], 0
v_mfma_f32_16x16x32_bf16 v[52:55], v[204:207], v[108:111], 0
v_mfma_f32_16x16x32_bf16 v[40:43], v[208:211], v[112:115], v[40:43]
v_mfma_f32_16x16x32_bf16 v[48:51], v[208:211], v[116:119], v[48:51]
v_mfma_f32_16x16x32_bf16 v[44:47], v[212:215], v[112:115], v[44:47]
v_mfma_f32_16x16x32_bf16 v[52:55], v[212:215], v[116:119], v[52:55]
v_mfma_f32_16x16x32_bf16 v[40:43], v[216:219], v[120:123], v[40:43]
v_mfma_f32_16x16x32_bf16 v[48:51], v[216:219], v[124:127], v[48:51]
v_mfma_f32_16x16x32_bf16 v[44:47], v[220:223], v[120:123], v[44:47]
v_mfma_f32_16x16x32_bf16 v[52:55], v[220:223], v[124:127], v[52:55]
v_mfma_f32_16x16x32_bf16 v[40:43], v[224:227], v[128:131], v[40:43]
v_mfma_f32_16x16x32_bf16 v[48:51], v[224:227], v[132:135], v[48:51]
v_mfma_f32_16x16x32_bf16 v[44:47], v[228:231], v[128:131], v[44:47]
v_mfma_f32_16x16x32_bf16 v[52:55], v[228:231], v[132:135], v[52:55]
s_nop 7
s_nop 7
v_max3_f32 v38, v40, v41, v38
v_max3_f32 v38, v42, v43, v38
v_max3_f32 v38, v44, v45, v38
v_max3_f32 v38, v46, v47, v38
v_max3_f32 v1, v48, v49, v1
v_max3_f32 v1, v50, v51, v1
v_max3_f32 v1, v52, v53, v1
v_max3_f32 v1, v54, v55, v1
s_add_u32 s22, s22, 8192
s_cmp_lt_u32 s22, 131072
s_cbranch_scc1 L_redo_loop
v_mov_b32 v6, v38
s_nop 1
v_permlane16_swap_b32 v6, v38
s_nop 1
v_max_f32 v38, v38, v6
v_mov_b32 v6, v38
s_nop 1
v_permlane32_swap_b32 v6, v38
s_nop 1
v_max_f32 v38, v38, v6
v_mov_b32 v6, v1
s_nop 1
v_permlane16_swap_b32 v6, v1
s_nop 1
v_max_f32 v1, v1, v6
v_mov_b32 v6, v1
s_nop 1
v_permlane32_swap_b32 v6, v1
s_nop 1
v_max_f32 v1, v1, v6
v_sub_f32 v1, 0, v1
v_mov_b32 v6, 0x100
v_mov_b32 v160, 0x1000
v_sub_f32 v38, 0, v38
s_mov_b64 s[48:49], 0
s_barrier
s_branch L_restart
L_cjob:
s_add_u32 s72, s98, 0
s_cmp_ge_u32 s72, 1152
s_cselect_b32 s3, 1152, 0
s_sub_u32 s72, s72, s3
s_lshl_b32 s76, s72, 6
s_add_u32 s76, s76, s62
s_add_u32 s72, s72, s99
s_add_u32 s73, s98, 512
s_cmp_ge_u32 s73, 1152
s_cselect_b32 s3, 1152, 0
s_sub_u32 s73, s73, s3
s_lshl_b32 s77, s73, 6
s_add_u32 s77, s77, s62
s_add_u32 s73, s73, s99
s_add_u32 s74, s98, 1024
s_cmp_ge_u32 s74, 1152
s_cselect_b32 s3, 1152, 0
s_sub_u32 s74, s74, s3
s_lshl_b32 s78, s74, 6
s_add_u32 s78, s78, s62
s_add_u32 s74, s74, s99
s_cmp_lg_u32 s70, 0
s_cbranch_scc1 L_p0
s_barrier
s_cmp_lg_u32 s69, 0
s_cbranch_scc1 L_g0
L_p0:
buffer_load_dword v115, v114, s[44:47], s71 offen offset:64 sc1
s_waitcnt vmcnt(0)
v_cmp_eq_u32 vcc, 0, v115
s_add_u32 s101, s101, 1
s_cmp_gt_u32 s101, 0x20000
s_cbranch_vccz L_g0
s_sleep 8
s_cbranch_scc0 L_p0
L_g0:
s_cmp_lg_u32 s70, 0
s_cbranch_scc1 L_h0
s_barrier
L_h0:
s_cmp_ge_u32 s69, 1
s_cbranch_scc1 L_l0
buffer_load_dwordx4 v[192:195], v108, s[44:47], s78 offen offset:0 sc1
buffer_load_dwordx4 v[196:199], v108, s[44:47], s78 offen offset:256 sc1
s_add_u32 s78, s78, 2048
buffer_load_dwordx4 v[200:203], v108, s[44:47], s78 offen offset:0 sc1
buffer_load_dwordx4 v[204:207], v108, s[44:47], s78 offen offset:256 sc1
s_add_u32 s78, s78, 2048
buffer_load_dwordx4 v[208:211], v108, s[44:47], s78 offen offset:0 sc1
buffer_load_dwordx4 v[212:215], v108, s[44:47], s78 offen offset:256 sc1
s_add_u32 s78, s78, 2048
buffer_load_dwordx4 v[216:219], v108, s[44:47], s78 offen offset:0 sc1
buffer_load_dwordx4 v[220:223], v108, s[44:47], s78 offen offset:256 sc1
L_l0:
buffer_load_dwordx4 v[160:163], v108, s[44:47], s77 offen offset:0 sc1
buffer_load_dwordx4 v[164:167], v108, s[44:47], s77 offen offset:256 sc1
s_add_u32 s77, s77, 2048
buffer_load_dwordx4 v[168:171], v108, s[44:47], s77 offen offset:0 sc1
buffer_load_dwordx4 v[172:175], v108, s[44:47], s77 offen offset:256 sc1
s_add_u32 s77, s77, 2048
buffer_load_dwordx4 v[176:179], v108, s[44:47], s77 offen offset:0 sc1
buffer_load_dwordx4 v[180:183], v108, s[44:47], s77 offen offset:256 sc1
s_add_u32 s77, s77, 2048
buffer_load_dwordx4 v[184:187], v108, s[44:47], s77 offen offset:0 sc1
buffer_load_dwordx4 v[188:191], v108, s[44:47], s77 offen offset:256 sc1
buffer_load_dwordx4 v[128:131], v108, s[44:47], s76 offen offset:0 sc1
buffer_load_dwordx4 v[132:135], v108, s[44:47], s76 offen offset:256 sc1
s_add_u32 s76, s76, 2048
buffer_load_dwordx4 v[136:139], v108, s[44:47], s76 offen offset:0 sc1
buffer_load_dwordx4 v[140:143], v108, s[44:47], s76 offen offset:256 sc1
s_add_u32 s76, s76, 2048
buffer_load_dwordx4 v[144:147], v108, s[44:47], s76 offen offset:0 sc1
buffer_load_dwordx4 v[148:151], v108, s[44:47], s76 offen offset:256 sc1
s_add_u32 s76, s76, 2048
buffer_load_dwordx4 v[152:155], v108, s[44:47], s76 offen offset:0 sc1
buffer_load_dwordx4 v[156:159], v108, s[44:47], s76 offen offset:256 sc1
s_cmp_ge_u32 s69, 1
s_cbranch_scc1 L_m0
s_waitcnt vmcnt(23)
v_mfma_f32_16x16x32_bf16 v[72:75], v[100:103], v[192:195], 0
s_waitcnt vmcnt(22)
v_mfma_f32_16x16x32_bf16 v[72:75], v[104:107], v[196:199], v[72:75]
s_waitcnt vmcnt(21)
v_mfma_f32_16x16x32_bf16 v[72:75], v[100:103], v[200:203], v[72:75]
s_waitcnt vmcnt(20)
v_mfma_f32_16x16x32_bf16 v[72:75], v[104:107], v[204:207], v[72:75]
s_waitcnt vmcnt(19)
v_mfma_f32_16x16x32_bf16 v[72:75], v[100:103], v[208:211], v[72:75]
s_waitcnt vmcnt(18)
v_mfma_f32_16x16x32_bf16 v[72:75], v[104:107], v[212:215], v[72:75]
s_waitcnt vmcnt(17)
v_mfma_f32_16x16x32_bf16 v[72:75], v[100:103], v[216:219], v[72:75]
s_waitcnt vmcnt(16)
v_mfma_f32_16x16x32_bf16 v[72:75], v[104:107], v[220:223], v[72:75]
L_m0:
s_waitcnt vmcnt(15)
v_mfma_f32_16x16x32_bf16 v[68:71], v[100:103], v[160:163], 0
s_waitcnt vmcnt(14)
v_mfma_f32_16x16x32_bf16 v[68:71], v[104:107], v[164:167], v[68:71]
s_waitcnt vmcnt(13)
v_mfma_f32_16x16x32_bf16 v[68:71], v[100:103], v[168:171], v[68:71]
s_waitcnt vmcnt(12)
v_mfma_f32_16x16x32_bf16 v[68:71], v[104:107], v[172:175], v[68:71]
s_waitcnt vmcnt(11)
v_mfma_f32_16x16x32_bf16 v[68:71], v[100:103], v[176:179], v[68:71]
s_waitcnt vmcnt(10)
v_mfma_f32_16x16x32_bf16 v[68:71], v[104:107], v[180:183], v[68:71]
s_waitcnt vmcnt(9)
v_mfma_f32_16x16x32_bf16 v[68:71], v[100:103], v[184:187], v[68:71]
s_waitcnt vmcnt(8)
v_mfma_f32_16x16x32_bf16 v[68:71], v[104:107], v[188:191], v[68:71]
s_waitcnt vmcnt(7)
v_mfma_f32_16x16x32_bf16 v[64:67], v[100:103], v[128:131], 0
s_waitcnt vmcnt(6)
v_mfma_f32_16x16x32_bf16 v[64:67], v[104:107], v[132:135], v[64:67]
s_waitcnt vmcnt(5)
v_mfma_f32_16x16x32_bf16 v[64:67], v[100:103], v[136:139], v[64:67]
s_waitcnt vmcnt(4)
v_mfma_f32_16x16x32_bf16 v[64:67], v[104:107], v[140:143], v[64:67]
s_waitcnt vmcnt(3)
v_mfma_f32_16x16x32_bf16 v[64:67], v[100:103], v[144:147], v[64:67]
s_waitcnt vmcnt(2)
v_mfma_f32_16x16x32_bf16 v[64:67], v[104:107], v[148:151], v[64:67]
s_waitcnt vmcnt(1)
v_mfma_f32_16x16x32_bf16 v[64:67], v[100:103], v[152:155], v[64:67]
s_waitcnt vmcnt(0)
v_mfma_f32_16x16x32_bf16 v[64:67], v[104:107], v[156:159], v[64:67]
s_nop 7
v_cvt_pk_bf16_f32 v80, v64, v65
v_cvt_pk_bf16_f32 v81, v66, v67
buffer_store_dwordx2 v[80:81], v109, s[24:27], s72 offen sc1
v_cvt_pk_bf16_f32 v82, v68, v69
v_cvt_pk_bf16_f32 v83, v70, v71
buffer_store_dwordx2 v[82:83], v109, s[24:27], s73 offen sc1
s_cmp_ge_u32 s69, 1
s_cbranch_scc1 L_s0
v_cvt_pk_bf16_f32 v84, v72, v73
v_cvt_pk_bf16_f32 v85, v74, v75
buffer_store_dwordx2 v[84:85], v109, s[24:27], s74 offen sc1
L_s0:
s_cmp_eq_u32 s67, 0
s_cbranch_scc1 L_cdone
L_cchunk:
s_ff1_i32_b32 s68, s67
s_bitset0_b32 s67, s68
s_mov_b32 s70, 1
s_mul_i32 s62, s68, 74240
s_lshr_b32 s3, s68, 3
s_and_b32 s99, s68, 3
s_lshl2_add_u32 s3, s3, s99
s_mul_i32 s3, s3, 9216
s_bfe_u32 s99, s68, 0x10002
s_lshl_b32 s99, s99, 6
s_add_u32 s99, s99, s3
s_lshr_b32 s3, s68, 2
s_lshl_b32 s3, s3, 7
s_add_u32 s71, s3, 73728
s_branch L_cjob
L_cslow:
s_barrier
s_lshl2_add_u32 s3, s80, 143360
v_lshl_add_u32 v112, v0, 4, s3
v_lshl_add_u32 v113, v0, 4, s56
s_mov_b32 exec_hi, 0
ds_read_b128 v[128:131], v112 offset:0
ds_read_b128 v[132:135], v112 offset:512
ds_read_b128 v[136:139], v112 offset:1024
ds_read_b128 v[140:143], v112 offset:1536
ds_read_b128 v[144:147], v112 offset:2048
ds_read_b128 v[148:151], v112 offset:2560
ds_read_b128 v[152:155], v112 offset:3072
ds_read_b128 v[156:159], v112 offset:3584
ds_read_b128 v[160:163], v112 offset:4096
s_waitcnt lgkmcnt(0)
s_lshl_b32 s3, s80, 6
s_add_u32 s3, s3, s62
buffer_store_dwordx4 v[128:131], v113, s[44:47], s3 offen sc1
s_lshl_b32 s3, s81, 6
s_add_u32 s3, s3, s62
buffer_store_dwordx4 v[132:135], v113, s[44:47], s3 offen sc1
s_lshl_b32 s3, s82, 6
s_add_u32 s3, s3, s62
buffer_store_dwordx4 v[136:139], v113, s[44:47], s3 offen sc1
s_lshl_b32 s3, s83, 6
s_add_u32 s3, s3, s62
buffer_store_dwordx4 v[140:143], v113, s[44:47], s3 offen sc1
s_lshl_b32 s3, s84, 6
s_add_u32 s3, s3, s62
buffer_store_dwordx4 v[144:147], v113, s[44:47], s3 offen sc1
s_lshl_b32 s3, s85, 6
s_add_u32 s3, s3, s62
buffer_store_dwordx4 v[148:151], v113, s[44:47], s3 offen sc1
s_lshl_b32 s3, s86, 6
s_add_u32 s3, s3, s62
buffer_store_dwordx4 v[152:155], v113, s[44:47], s3 offen sc1
s_lshl_b32 s3, s87, 6
s_add_u32 s3, s3, s62
buffer_store_dwordx4 v[156:159], v113, s[44:47], s3 offen sc1
s_lshl_b32 s3, s88, 6
s_add_u32 s3, s3, s62
buffer_store_dwordx4 v[160:163], v113, s[44:47], s3 offen sc1
s_waitcnt vmcnt(0)
s_mov_b32 exec_hi, -1
s_mov_b32 s70, 0
L_cs1:
buffer_load_dword v110, v111, s[36:39], 0 offen sc1
s_waitcnt vmcnt(0)
v_readfirstlane_b32 s67, v110
s_and_b32 s3, s67, 0xffff
s_cmp_eq_u32 s3, 16
s_cbranch_scc1 L_cs2
s_add_u32 s70, s70, 1
s_cmp_lt_u32 s70, 4096
s_cbranch_scc1 L_cs1
s_add_u32 s3, s52, 16
s_lshl_b32 s3, 1, s3
v_mov_b32 v110, s3
s_mov_b64 exec, 1
buffer_atomic_or v110, v111, s[36:39], 0 offen sc0 sc1
s_waitcnt vmcnt(0)
s_mov_b64 exec, -1
v_readfirstlane_b32 s67, v110
s_and_b32 s3, s67, 0xffff
s_cmp_eq_u32 s3, 16
s_cbranch_scc0 L_cdone
L_cs2:
s_lshr_b32 s67, s67, 16
s_bitset1_b32 s67, s52
s_branch L_cchunk
.section .rodata,"a"
.p2align 6
.amdhsa_kernel standalone__gqa_block_cached__near_ridge_kernel
  .amdhsa_next_free_vgpr 256
  .amdhsa_next_free_sgpr 102
  .amdhsa_accum_offset 256
  .amdhsa_group_segment_fixed_size 0
  .amdhsa_kernarg_size 64
  .amdhsa_user_sgpr_count 2
  .amdhsa_user_sgpr_kernarg_segment_ptr 1
  .amdhsa_system_sgpr_workgroup_id_x 1
.end_amdhsa_kernel
.text
```
